```python
import torch

def _softmax(x, axis=-1):
    return torch.softmax(x, dim=axis)
def _gelu(x):
    return torch.nn.functional.gelu(x, approximate="tanh")
def _silu(x):
    return torch.nn.functional.silu(x)
def _sigmoid(x):
    return torch.sigmoid(x)
def _layernorm(x, axis=-1, eps=1e-5):
    m = x.mean(dim=axis, keepdim=True)
    v = x.var(dim=axis, keepdim=True, unbiased=False)
    return (x - m) / torch.sqrt(v + eps)
def _scatter_add(tgt, idx, src, axis=0):
    return tgt.clone().index_add_(axis, idx, src)
def _segment_sum(src, seg, n):
    out = torch.zeros((n,) + src.shape[1:], dtype=src.dtype)
    return out.index_add_(0, seg, src)
def _pad(x, pw):
    flat = tuple(v for pair in reversed(pw) for v in pair)
    return torch.nn.functional.pad(x, flat)

kernel_name = 'gated_mix__compressed_kv_cla__mixer_token_mlp__decode'

def setup_inputs():

    _w = (lambda a: (lambda t: t.to(torch.bfloat16) if t.is_floating_point() else t)(torch.as_tensor(a)))
    def _A_setup():
        B, H, Sq, Sk, D, M = 4, 32, 1, 4096, 128, 576
        Dc = 4 * D
        return {
            "x": _w((lambda *s: torch.randn(*s, dtype=torch.bfloat16) * 0.05)(B, Sq, M)),
            "c_kv": _w((lambda *s: torch.randn(*s, dtype=torch.bfloat16) * 0.4)(B, Sk, Dc)),
            "w_q": _w((lambda *s: torch.randn(*s, dtype=torch.bfloat16) * 3.2)(M, H, D) * (M ** -0.5)),
            "w_uk": _w((lambda *s: torch.randn(*s, dtype=torch.bfloat16) * 3.2)(Dc, H, D) * (Dc ** -0.5)),
            "w_uv": _w((lambda *s: torch.randn(*s, dtype=torch.bfloat16) * 0.4)(Dc, H, D) * (Dc ** -0.5)),
            "w_o": _w((lambda *s: torch.randn(*s, dtype=torch.bfloat16) * 0.4)(H, D, M) * ((H * D) ** -0.5)),
        }
    _A_in = _A_setup()

    def _B_setup():
        B, S, D, F = 4, 1, 576, 4608
        return {
            "x": _w((lambda *s: torch.randn(*s, dtype=torch.bfloat16) * 0.05)(B, S, D)),
            "w1": _w((lambda *s: torch.randn(*s, dtype=torch.bfloat16) * 0.05)(S, F) * (S ** -0.5)),
            "b1": _w((lambda *s: torch.randn(*s, dtype=torch.bfloat16) * 0.05)(F) * 0.02),
            "w2": _w((lambda *s: torch.randn(*s, dtype=torch.bfloat16) * 0.05)(F, S) * (F ** -0.5)),
            "b2": _w((lambda *s: torch.randn(*s, dtype=torch.bfloat16) * 0.05)(S) * 0.02),
        }
    _B_in = _B_setup()

    return {
        "A_x": _A_in["x"],
        "A_c_kv": _A_in["c_kv"],
        "A_w_q": _A_in["w_q"],
        "A_w_uk": _A_in["w_uk"],
        "A_w_uv": _A_in["w_uv"],
        "A_w_o": _A_in["w_o"],
        "B_x": _B_in["x"],
        "B_w1": _B_in["w1"],
        "B_b1": _B_in["b1"],
        "B_w2": _B_in["w2"],
        "B_b2": _B_in["b2"],
        "gate_w": _w((lambda *s: torch.randn(*s, dtype=torch.bfloat16) * 0.05)(576) * 16.0),
    }

def reference(A_x, A_c_kv, A_w_q, A_w_uk, A_w_uv, A_w_o, B_x, B_w1, B_b1, B_w2, B_b2, gate_w):
    def _A_ref(x, c_kv, w_q, w_uk, w_uv, w_o):
        B, Sq, M = x.shape[0], x.shape[1], x.shape[2]
        Sk = c_kv.shape[1]
        H, D = w_q.shape[1], w_q.shape[2]
        q = torch.einsum("bqm,mhd->bhqd", x, w_q)
        k = torch.einsum("bkc,chd->bhkd", c_kv, w_uk)
        v = torch.einsum("bkc,chd->bhkd", c_kv, w_uv)
        scores = torch.einsum("bhqd,bhkd->bhqk", q, k) * (D ** -0.5)
        off = Sk - Sq
        qi = torch.arange(Sq)[:, None]
        kj = torch.arange(Sk)[None, :]
        cmask = kj <= (qi + off)
        scores = torch.where(cmask[None, None], scores, -1e9)
        p = _softmax(scores, axis=-1)
        ctx = torch.einsum("bhqk,bhkd->bhqd", p, v)
        return torch.einsum("bhqd,hdm->bqm", ctx, w_o)

    def _B_ref(x, w1, b1, w2, b2):
        B, S, D = x.shape
        h = _layernorm(x, axis=-1)
        u = torch.einsum("bsd,sf->bdf", h, w1) + b1
        u = _gelu(u)
        y = torch.einsum("bdf,fs->bds", u, w2) + b2
        return (lambda x, *d: x.permute(*d))(y, 0, 2, 1)

    x = A_x
    g = _sigmoid((x * gate_w).sum(-1, keepdims=True))
    a = _A_ref(x, A_c_kv, A_w_q, A_w_uk, A_w_uv, A_w_o)
    b = _B_ref(x, B_w1, B_b1, B_w2, B_b2)
    return g * a + (1 - g) * b
```

```asm
; @launch grid=(256,1,1) block=(512,1,1) lds=163840
.amdgcn_target "amdgcn-amd-amdhsa--gfx950"
.text
.globl gated_mix__compressed_kv_cla__mixer_token_mlp__decode_kernel
.p2align 8
.type gated_mix__compressed_kv_cla__mixer_token_mlp__decode_kernel,@function
gated_mix__compressed_kv_cla__mixer_token_mlp__decode_kernel:
  s_cmp_ge_u32 s2, 256
  s_cbranch_scc1 L_end
  s_load_dwordx16 s[4:19], s[0:1], 0
  s_load_dwordx8 s[20:27], s[0:1], 64
  s_load_dwordx4 s[28:31], s[0:1], 96
  s_load_dwordx2 s[32:33], s[0:1], 112
  v_and_b32 v1, 63, v0
  v_lshrrev_b32 v4, 6, v0
  v_and_b32 v2, 15, v1
  v_readfirstlane_b32 s36, v4
  v_lshrrev_b32 v3, 4, v1
  s_and_b32 s37, s2, 7
  s_lshr_b32 s38, s2, 3
  s_mov_b32 s58, 0x000f000f
  s_mov_b32 s59, 0x000f000f
  s_cmp_lg_u32 s36, 6
  s_cbranch_scc1 L_nopf
  s_getpc_b64 s[60:61]
L_pc:
  s_lshl_b32 s62, s38, 10
  v_lshl_add_u32 v5, v1, 4, s62
  v_min_u32 v5, L_text_end-L_pc-16, v5
  global_load_dwordx4 v[252:255], v5, s[60:61]
L_nopf:
  s_waitcnt lgkmcnt(0)
  s_add_u32 s32, s32, 0
  s_addc_u32 s33, s33, 0
  s_and_b32 s43, s38, 15
  s_lshl_b32 s48, s37, 4
  s_add_u32 s43, s43, s48
  s_cmp_ge_u32 s38, 16
  s_cbranch_scc1 L_A
  s_load_dword s34, s[32:33], 0
  s_lshr_b32 s39, s43, 2
  s_and_b32 s40, s43, 3
  s_mul_i32 s60, s40, 9
  s_lshr_b32 s60, s60, 1
  v_lshrrev_b32 v5, 3, v1
  v_and_b32 v6, 6, v5
  v_and_b32 v4, 7, v1
  v_xor_b32 v6, v6, v4
  v_lshlrev_b32 v6, 4, v6
  v_mul_u32_u24 v5, 8192, v5
  v_add_u32 v4, v5, v6
  s_mov_b32 s44, s8
  s_and_b32 s45, s9, 0xffff
  s_mov_b32 s46, 4718592
  s_mov_b32 s47, 0x00020000
  s_lshl_b32 s50, s60, 18
  s_lshr_b32 s48, s36, 1
  s_lshl_b32 s48, s48, 16
  s_add_u32 s50, s50, s48
  s_lshl_b32 s48, s39, 8
  s_add_u32 s50, s50, s48
  s_and_b32 s48, s36, 1
  s_lshl_b32 s48, s48, 7
  s_add_u32 s50, s50, s48
  s_lshl_b32 m0, s36, 10
  s_sub_u32 s51, 18, s60
  s_mov_b32 s61, 4290510848
  buffer_load_dwordx4 v4, s[44:47], s50 offen lds
  s_cmp_eq_u32 s51, 1
  s_cselect_b32 s48, s61, 262144
  s_add_u32 s50, s50, s48
  s_add_u32 m0, m0, 8192
  s_nop 0
  buffer_load_dwordx4 v4, s[44:47], s50 offen lds
  s_cmp_eq_u32 s51, 2
  s_cselect_b32 s48, s61, 262144
  s_add_u32 s50, s50, s48
  s_add_u32 m0, m0, 8192
  s_nop 0
  buffer_load_dwordx4 v4, s[44:47], s50 offen lds
  s_cmp_eq_u32 s51, 3
  s_cselect_b32 s48, s61, 262144
  s_add_u32 s50, s50, s48
  s_add_u32 m0, m0, 8192
  s_mov_b32 s52, m0
  s_cmp_ge_u32 s36, 5
  s_cbranch_scc1 L_xr_1
  s_mov_b32 s48, 59652324
  v_mul_hi_u32 v6, v0, s48
  v_mul_u32_u24 v6, 72, v6
  v_sub_u32 v7, v0, v6
  s_lshl_b32 s48, s60, 2
  v_add_u32 v7, s48, v7
  v_subrev_u32 v8, 72, v7
  v_min_u32 v7, v7, v8
  v_add_lshl_u32 v7, v7, v6, 4
  s_mov_b32 s96, s4
  s_and_b32 s97, s5, 0xffff
  s_mov_b32 s98, 4608
  s_mov_b32 s99, 0x00020000
  s_lshl_b32 s48, s36, 10
  s_add_u32 m0, s48, 147456
  v_lshlrev_b32 v8, 4, v0
  buffer_load_dwordx4 v7, s[96:99], 0 offen lds
  s_add_u32 m0, s48, 156672
  s_nop 0
  buffer_load_dwordx4 v8, s[96:99], 0 offen lds
  s_branch L_xr_1_d
L_xr_1:
  v_lshlrev_b32 v8, 4, v1
  s_and_b32 s48, s40, 3
  s_and_b32 s49, s39, 3
  s_lshl_b32 s49, s49, 2
  s_add_u32 s48, s48, s49
  s_mul_i32 s48, s48, 576
  s_mov_b32 s99, 0x00020000
  s_cmp_eq_u32 s36, 5
  s_cbranch_scc0 L_xr_1_6
  s_mov_b32 s96, s26
  s_and_b32 s97, s27, 0xffff
  s_mov_b32 s98, 1152
  s_mov_b32 m0, 153664
  s_mov_b32 s48, 1024
  buffer_load_dwordx4 v8, s[96:99], 0 offen lds
  s_mov_b32 m0, 154688
  s_mov_b64 exec, 0xff
  buffer_load_dwordx4 v8, s[96:99], s48 offen lds
  s_mov_b64 exec, -1
  s_branch L_xr_1_d
L_xr_1_6:
  s_mov_b32 s98, 9216
  s_mov_b32 exec_hi, 0xf
  s_cmp_eq_u32 s36, 6
  s_cbranch_scc0 L_xr_1_7
  s_mov_b32 s96, s18
  s_and_b32 s97, s19, 0xffff
  s_mov_b32 m0, 154816
  s_nop 0
  buffer_load_dwordx4 v8, s[96:99], s48 offen lds
  s_mov_b32 s96, s20
  s_and_b32 s97, s21, 0xffff
  s_mov_b32 m0, 155392
  s_nop 0
  buffer_load_dwordx4 v8, s[96:99], s48 offen lds
  s_mov_b64 exec, -1
  s_branch L_xr_1_d
L_xr_1_7:
  s_mov_b32 s96, s22
  s_and_b32 s97, s23, 0xffff
  s_mov_b32 m0, 155968
  s_nop 0
  buffer_load_dwordx4 v8, s[96:99], s48 offen lds
  s_mov_b64 exec, -1
L_xr_1_d:
  s_mov_b32 m0, s52
  s_load_dword s53, s[24:25], 0
  buffer_load_dwordx4 v4, s[44:47], s50 offen lds
  s_cmp_eq_u32 s51, 4
  s_cselect_b32 s48, s61, 262144
  s_add_u32 s50, s50, s48
  s_add_u32 m0, m0, 8192
  s_nop 0
  buffer_load_dwordx4 v4, s[44:47], s50 offen lds
  s_cmp_eq_u32 s51, 5
  s_cselect_b32 s48, s61, 262144
  s_add_u32 s50, s50, s48
  s_add_u32 m0, m0, 8192
  s_nop 0
  buffer_load_dwordx4 v4, s[44:47], s50 offen lds
  s_cmp_eq_u32 s51, 6
  s_cselect_b32 s48, s61, 262144
  s_add_u32 s50, s50, s48
  s_add_u32 m0, m0, 8192
  s_mov_b32 s41, s43
  s_and_b32 s48, s36, 3
  s_lshr_b32 s49, s36, 2
  s_lshl_b32 s49, s49, 10
  v_lshrrev_b32 v5, 2, v2
  v_bfe_u32 v6, v2, 1, 1
  v_lshl_add_u32 v6, s48, 1, v6
  v_and_b32 v7, 2, v5
  v_xor_b32 v6, v6, v7
  v_lshlrev_b32 v6, 4, v6
  v_lshl_add_u32 v6, v5, 7, v6
  v_and_b32 v7, 1, v2
  v_lshl_add_u32 v6, v7, 3, v6
  v_lshl_add_u32 v6, v3, 11, v6
  v_add_u32 v10, s49, v6
  v_xor_b32 v13, 64, v10
  v_add_u32 v13, 512, v13
  v_add_u32 v11, 0x10000, v10
  v_add_u32 v12, 0x20000, v10
  v_add_u32 v14, 0x10000, v13
  v_add_u32 v15, 0x20000, v13
  v_and_b32 v5, 3, v2
  v_mul_u32_u24 v16, 1152, v5
  v_lshl_add_u32 v16, v3, 4, v16
  v_add_u32 v16, 147456, v16
  v_mul_u32_u24 v18, 272, v5
  v_add_u32 v18, 152576, v18
  v_lshl_add_u32 v17, v3, 3, v18
  s_lshl_b32 s48, s36, 5
  v_add_u32 v17, s48, v17
  v_lshl_add_u32 v18, v3, 4, v18
  s_lshl_b32 s48, s39, 7
  s_lshl_b32 s49, s40, 5
  s_add_u32 s48, s48, s49
  s_lshl_b32 s49, s36, 2
  s_add_u32 s48, s48, s49
  v_lshl_add_u32 v19, v2, 12, v3
  v_add_u32 v19, s48, v19
  v_lshlrev_b32 v19, 4, v19
  v_add_u32 v19, 528384, v19
  s_lshl_b32 s48, s40, 7
  s_lshl_b32 s49, s36, 4
  s_add_u32 s48, s48, s49
  v_add_u32 v20, s48, v2
  v_lshlrev_b32 v20, 13, v20
  v_lshl_add_u32 v20, v3, 4, v20
  s_lshl_b32 s48, s39, 8
  v_add_u32 v20, s48, v20
  v_and_b32 v5, 7, v2
  v_and_b32 v6, 6, v5
  v_xor_b32 v6, v6, v3
  v_lshlrev_b32 v6, 4, v6
  v_lshl_add_u32 v6, v5, 7, v6
  v_lshrrev_b32 v5, 3, v2
  s_lshl_b32 s49, s36, 1
  v_add_u32 v5, s49, v5
  v_lshl_add_u32 v20, v5, 11, v6
  v_add_u32 v20, 36864, v20
  v_xor_b32 v21, 64, v20
  buffer_load_dwordx4 v4, s[44:47], s50 offen lds
  s_cmp_eq_u32 s51, 7
  s_cselect_b32 s48, s61, 262144
  s_add_u32 s50, s50, s48
  s_add_u32 m0, m0, 8192
  s_nop 0
  buffer_load_dwordx4 v4, s[44:47], s50 offen lds
  s_cmp_eq_u32 s51, 8
  s_cselect_b32 s48, s61, 262144
  s_add_u32 s50, s50, s48
  s_add_u32 m0, m0, 8192
  s_nop 0
  buffer_load_dwordx4 v4, s[44:47], s50 offen lds
  s_cmp_eq_u32 s51, 9
  s_cselect_b32 s48, s61, 262144
  s_add_u32 s50, s50, s48
  s_add_u32 m0, m0, 8192
  s_waitcnt vmcnt(6)
  s_barrier
  ds_read_b64_tr_b16 v[48:49], v10 offset:0
  ds_read_b64_tr_b16 v[50:51], v13 offset:0
  ds_read_b128 v[60:63], v16 offset:0
  ds_read_b64_tr_b16 v[52:53], v10 offset:8192
  ds_read_b64_tr_b16 v[54:55], v13 offset:8192
  ds_read_b128 v[64:67], v16 offset:64
  ds_read_b64_tr_b16 v[56:57], v10 offset:16384
  ds_read_b64_tr_b16 v[58:59], v13 offset:16384
  ds_read_b128 v[68:71], v16 offset:128
  s_waitcnt lgkmcnt(6)
  v_mfma_f32_16x16x32_bf16 v[72:75], v[48:51], v[60:63], 0
  s_waitcnt lgkmcnt(3)
  v_mfma_f32_16x16x32_bf16 v[72:75], v[52:55], v[64:67], v[72:75]
  s_waitcnt lgkmcnt(0)
  v_mfma_f32_16x16x32_bf16 v[72:75], v[56:59], v[68:71], v[72:75]
  buffer_load_dwordx4 v4, s[44:47], s50 offen lds
  s_cmp_eq_u32 s51, 10
  s_cselect_b32 s48, s61, 262144
  s_add_u32 s50, s50, s48
  s_add_u32 m0, m0, 8192
  s_nop 0
  buffer_load_dwordx4 v4, s[44:47], s50 offen lds
  s_cmp_eq_u32 s51, 11
  s_cselect_b32 s48, s61, 262144
  s_add_u32 s50, s50, s48
  s_add_u32 m0, m0, 8192
  s_nop 0
  buffer_load_dwordx4 v4, s[44:47], s50 offen lds
  s_cmp_eq_u32 s51, 12
  s_cselect_b32 s48, s61, 262144
  s_add_u32 s50, s50, s48
  s_add_u32 m0, m0, 8192
  s_waitcnt vmcnt(6)
  s_barrier
  ds_read_b64_tr_b16 v[48:49], v10 offset:24576
  ds_read_b64_tr_b16 v[50:51], v13 offset:24576
  ds_read_b128 v[60:63], v16 offset:192
  ds_read_b64_tr_b16 v[52:53], v10 offset:32768
  ds_read_b64_tr_b16 v[54:55], v13 offset:32768
  ds_read_b128 v[64:67], v16 offset:256
  ds_read_b64_tr_b16 v[56:57], v10 offset:40960
  ds_read_b64_tr_b16 v[58:59], v13 offset:40960
  ds_read_b128 v[68:71], v16 offset:320
  s_waitcnt lgkmcnt(6)
  v_mfma_f32_16x16x32_bf16 v[72:75], v[48:51], v[60:63], v[72:75]
  s_waitcnt lgkmcnt(3)
  v_mfma_f32_16x16x32_bf16 v[72:75], v[52:55], v[64:67], v[72:75]
  s_waitcnt lgkmcnt(0)
  v_mfma_f32_16x16x32_bf16 v[72:75], v[56:59], v[68:71], v[72:75]
  s_cmp_ge_u32 s36, 4
  s_cbranch_scc1 L_su_2
  s_mul_i32 s48, s36, 1152
  s_add_u32 s48, s48, 156672
  v_lshl_add_u32 v128, v1, 2, s48
  v_lshlrev_b32 v134, 2, v1
  v_add_u32 v134, 153664, v134
  ds_read_b32 v129, v128 offset:0
  ds_read_b32 v136, v134 offset:0
  ds_read_b32 v130, v128 offset:256
  ds_read_b32 v137, v134 offset:256
  ds_read_b32 v131, v128 offset:512
  ds_read_b32 v138, v134 offset:512
  ds_read_b32 v132, v128 offset:768
  ds_read_b32 v139, v134 offset:768
  ds_read_b32 v133, v128 offset:1024
  ds_read_b32 v140, v134 offset:1024
  v_cmp_gt_u32 s[62:63], 32, v1
  s_waitcnt lgkmcnt(0)
  v_lshlrev_b32 v96, 16, v129
  v_and_b32 v97, 0xffff0000, v129
  v_lshlrev_b32 v106, 16, v136
  v_and_b32 v107, 0xffff0000, v136
  v_lshlrev_b32 v98, 16, v130
  v_and_b32 v99, 0xffff0000, v130
  v_lshlrev_b32 v108, 16, v137
  v_and_b32 v109, 0xffff0000, v137
  v_lshlrev_b32 v100, 16, v131
  v_and_b32 v101, 0xffff0000, v131
  v_lshlrev_b32 v110, 16, v138
  v_and_b32 v111, 0xffff0000, v138
  v_lshlrev_b32 v102, 16, v132
  v_and_b32 v103, 0xffff0000, v132
  v_lshlrev_b32 v112, 16, v139
  v_and_b32 v113, 0xffff0000, v139
  v_lshlrev_b32 v104, 16, v133
  v_and_b32 v105, 0xffff0000, v133
  v_lshlrev_b32 v114, 16, v140
  v_and_b32 v115, 0xffff0000, v140
  v_cndmask_b32 v104, 0, v104, s[62:63]
  v_cndmask_b32 v105, 0, v105, s[62:63]
  v_cndmask_b32 v114, 0, v114, s[62:63]
  v_cndmask_b32 v115, 0, v115, s[62:63]
  v_add_f32 v142, v96, v97
  v_mul_f32 v143, v96, v106
  v_add_f32 v142, v142, v98
  v_add_f32 v142, v142, v99
  v_add_f32 v142, v142, v100
  v_add_f32 v142, v142, v101
  v_add_f32 v142, v142, v102
  v_add_f32 v142, v142, v103
  v_add_f32 v142, v142, v104
  v_add_f32 v142, v142, v105
  v_fmac_f32 v143, v97, v107
  v_fmac_f32 v143, v98, v108
  v_fmac_f32 v143, v99, v109
  v_fmac_f32 v143, v100, v110
  v_fmac_f32 v143, v101, v111
  v_fmac_f32 v143, v102, v112
  v_fmac_f32 v143, v103, v113
  v_fmac_f32 v143, v104, v114
  v_fmac_f32 v143, v105, v115
L_su_2:
  buffer_load_dwordx4 v4, s[44:47], s50 offen lds
  s_cmp_eq_u32 s51, 13
  s_cselect_b32 s48, s61, 262144
  s_add_u32 s50, s50, s48
  s_add_u32 m0, m0, 8192
  s_nop 0
  buffer_load_dwordx4 v4, s[44:47], s50 offen lds
  s_cmp_eq_u32 s51, 14
  s_cselect_b32 s48, s61, 262144
  s_add_u32 s50, s50, s48
  s_add_u32 m0, m0, 8192
  s_nop 0
  buffer_load_dwordx4 v4, s[44:47], s50 offen lds
  s_cmp_eq_u32 s51, 15
  s_cselect_b32 s48, s61, 262144
  s_add_u32 s50, s50, s48
  s_add_u32 m0, m0, 8192
  s_waitcnt vmcnt(6)
  s_barrier
  ds_read_b64_tr_b16 v[48:49], v10 offset:49152
  ds_read_b64_tr_b16 v[50:51], v13 offset:49152
  ds_read_b128 v[60:63], v16 offset:384
  ds_read_b64_tr_b16 v[52:53], v10 offset:57344
  ds_read_b64_tr_b16 v[54:55], v13 offset:57344
  ds_read_b128 v[64:67], v16 offset:448
  ds_read_b64_tr_b16 v[56:57], v11 offset:0
  ds_read_b64_tr_b16 v[58:59], v14 offset:0
  ds_read_b128 v[68:71], v16 offset:512
  s_waitcnt lgkmcnt(6)
  v_mfma_f32_16x16x32_bf16 v[72:75], v[48:51], v[60:63], v[72:75]
  s_waitcnt lgkmcnt(3)
  v_mfma_f32_16x16x32_bf16 v[72:75], v[52:55], v[64:67], v[72:75]
  s_waitcnt lgkmcnt(0)
  v_mfma_f32_16x16x32_bf16 v[72:75], v[56:59], v[68:71], v[72:75]
  s_cmp_ge_u32 s36, 4
  s_cbranch_scc1 L_su_3
  v_add_f32_dpp v142, v142, v142 row_ror:8 row_mask:0xf bank_mask:0xf
  v_add_f32_dpp v143, v143, v143 row_ror:8 row_mask:0xf bank_mask:0xf
  s_nop 0
  v_add_f32_dpp v142, v142, v142 row_ror:4 row_mask:0xf bank_mask:0xf
  v_add_f32_dpp v143, v143, v143 row_ror:4 row_mask:0xf bank_mask:0xf
  s_nop 0
  v_add_f32_dpp v142, v142, v142 row_ror:2 row_mask:0xf bank_mask:0xf
  v_add_f32_dpp v143, v143, v143 row_ror:2 row_mask:0xf bank_mask:0xf
  s_nop 0
  v_add_f32_dpp v142, v142, v142 row_ror:1 row_mask:0xf bank_mask:0xf
  v_add_f32_dpp v143, v143, v143 row_ror:1 row_mask:0xf bank_mask:0xf
  v_mov_b32 v144, v142
  v_mov_b32 v146, v143
  s_nop 0
  v_permlane16_swap_b32 v142, v144
  v_permlane16_swap_b32 v143, v146
  v_add_f32 v142, v142, v144
  v_add_f32 v143, v143, v146
  v_mov_b32 v144, v142
  v_mov_b32 v146, v143
  s_nop 0
  v_permlane32_swap_b32 v142, v144
  v_permlane32_swap_b32 v143, v146
  v_add_f32 v142, v142, v144
  v_add_f32 v143, v143, v146
  s_mov_b32 s48, 0x3ae38e39
  v_mul_f32 v142, s48, v142
  v_sub_f32 v96, v96, v142
  v_sub_f32 v97, v97, v142
  v_sub_f32 v98, v98, v142
  v_sub_f32 v99, v99, v142
  v_sub_f32 v100, v100, v142
  v_sub_f32 v101, v101, v142
  v_sub_f32 v102, v102, v142
  v_sub_f32 v103, v103, v142
  v_sub_f32 v104, v104, v142
  v_sub_f32 v105, v105, v142
  v_cndmask_b32 v104, 0, v104, s[62:63]
  v_cndmask_b32 v105, 0, v105, s[62:63]
  v_mul_f32 v145, v96, v96
  v_fmac_f32 v145, v97, v97
  v_fmac_f32 v145, v98, v98
  v_fmac_f32 v145, v99, v99
  v_fmac_f32 v145, v100, v100
  v_fmac_f32 v145, v101, v101
  v_fmac_f32 v145, v102, v102
  v_fmac_f32 v145, v103, v103
  v_fmac_f32 v145, v104, v104
  v_fmac_f32 v145, v105, v105
L_su_3:
  buffer_load_dwordx4 v4, s[44:47], s50 offen lds
  s_cmp_eq_u32 s51, 16
  s_cselect_b32 s48, s61, 262144
  s_add_u32 s50, s50, s48
  s_add_u32 m0, m0, 8192
  s_nop 0
  buffer_load_dwordx4 v4, s[44:47], s50 offen lds
  s_cmp_eq_u32 s51, 17
  s_cselect_b32 s48, s61, 262144
  s_add_u32 s50, s50, s48
  s_add_u32 m0, m0, 8192
  s_nop 0
  buffer_load_dwordx4 v4, s[44:47], s50 offen lds
  s_cmp_eq_u32 s51, 18
  s_cselect_b32 s48, s61, 262144
  s_add_u32 s50, s50, s48
  s_add_u32 m0, m0, 8192
  s_waitcnt vmcnt(6)
  s_barrier
  ds_read_b64_tr_b16 v[48:49], v11 offset:8192
  ds_read_b64_tr_b16 v[50:51], v14 offset:8192
  ds_read_b128 v[60:63], v16 offset:576
  ds_read_b64_tr_b16 v[52:53], v11 offset:16384
  ds_read_b64_tr_b16 v[54:55], v14 offset:16384
  ds_read_b128 v[64:67], v16 offset:640
  ds_read_b64_tr_b16 v[56:57], v11 offset:24576
  ds_read_b64_tr_b16 v[58:59], v14 offset:24576
  ds_read_b128 v[68:71], v16 offset:704
  s_waitcnt lgkmcnt(6)
  v_mfma_f32_16x16x32_bf16 v[72:75], v[48:51], v[60:63], v[72:75]
  s_waitcnt lgkmcnt(3)
  v_mfma_f32_16x16x32_bf16 v[72:75], v[52:55], v[64:67], v[72:75]
  s_waitcnt lgkmcnt(0)
  v_mfma_f32_16x16x32_bf16 v[72:75], v[56:59], v[68:71], v[72:75]
  s_cmp_ge_u32 s36, 4
  s_cbranch_scc1 L_su_4
  v_add_f32_dpp v145, v145, v145 row_ror:8 row_mask:0xf bank_mask:0xf
  s_nop 1
  v_add_f32_dpp v145, v145, v145 row_ror:4 row_mask:0xf bank_mask:0xf
  s_nop 1
  v_add_f32_dpp v145, v145, v145 row_ror:2 row_mask:0xf bank_mask:0xf
  s_nop 1
  v_add_f32_dpp v145, v145, v145 row_ror:1 row_mask:0xf bank_mask:0xf
  v_mov_b32 v144, v145
  s_nop 1
  v_permlane16_swap_b32 v145, v144
  v_add_f32 v145, v145, v144
  v_mov_b32 v144, v145
  s_nop 1
  v_permlane32_swap_b32 v145, v144
  v_add_f32 v145, v145, v144
  s_mov_b32 s48, 0x3ae38e39
  v_mov_b32 v144, 0x3727c5ac
  v_fmac_f32 v144, s48, v145
  v_rsq_f32 v145, v144
  s_mov_b32 s49, 0xbfb8aa3b
  v_mul_f32 v143, s49, v143
  v_exp_f32 v143, v143
  s_nop 0
  v_add_f32 v143, 1.0, v143
  v_rcp_f32 v143, v143
  s_lshl_b32 s48, s36, 4
  s_add_u32 s48, s48, 162944
  v_mov_b32 v144, s48
  v_mov_b32 v97, v142
  v_mov_b32 v98, v145
  v_mov_b32 v99, 0
  v_mov_b32 v96, v143
  s_mov_b64 exec, 1
  ds_write_b128 v144, v[96:99]
  s_mov_b64 exec, -1
L_su_4:
  s_mov_b32 s44, s10
  s_and_b32 s45, s11, 0xffff
  s_mov_b32 s46, 4194304
  s_mov_b32 s47, 0x00020000
  s_lshl_b32 s48, s40, 20
  s_lshr_b32 s49, s36, 1
  s_lshl_b32 s49, s49, 16
  s_add_u32 s48, s48, s49
  s_lshl_b32 s49, s39, 8
  s_add_u32 s48, s48, s49
  s_and_b32 s49, s36, 1
  s_lshl_b32 s49, s49, 7
  s_add_u32 s48, s48, s49
  s_lshl_b32 s49, s36, 10
  s_add_u32 m0, s49, 36864
  s_nop 0
  buffer_load_dwordx4 v4, s[44:47], s48 offen lds
  s_add_u32 s48, s48, 262144
  s_add_u32 m0, m0, 8192
  s_nop 0
  buffer_load_dwordx4 v4, s[44:47], s48 offen lds
  s_add_u32 s48, s48, 262144
  s_add_u32 m0, m0, 8192
  s_nop 0
  buffer_load_dwordx4 v4, s[44:47], s48 offen lds
  s_add_u32 s48, s48, 262144
  s_add_u32 m0, m0, 8192
  s_nop 0
  buffer_load_dwordx4 v4, s[44:47], s48 offen lds
  s_waitcnt vmcnt(7)
  s_barrier
  ds_read_b64_tr_b16 v[48:49], v11 offset:32768
  ds_read_b64_tr_b16 v[50:51], v14 offset:32768
  ds_read_b128 v[60:63], v16 offset:768
  ds_read_b64_tr_b16 v[52:53], v11 offset:40960
  ds_read_b64_tr_b16 v[54:55], v14 offset:40960
  ds_read_b128 v[64:67], v16 offset:832
  ds_read_b64_tr_b16 v[56:57], v11 offset:49152
  ds_read_b64_tr_b16 v[58:59], v14 offset:49152
  ds_read_b128 v[68:71], v16 offset:896
  s_waitcnt lgkmcnt(6)
  v_mfma_f32_16x16x32_bf16 v[72:75], v[48:51], v[60:63], v[72:75]
  s_waitcnt lgkmcnt(3)
  v_mfma_f32_16x16x32_bf16 v[72:75], v[52:55], v[64:67], v[72:75]
  s_waitcnt lgkmcnt(0)
  v_mfma_f32_16x16x32_bf16 v[72:75], v[56:59], v[68:71], v[72:75]
  v_mov_b32 v134, 0
  v_lshlrev_b32 v135, 2, v0
  v_add_u32 v135, 161792, v135
  s_cmp_ge_u32 s36, 5
  s_cbranch_scc1 L_su_5
  v_min_u32 v148, 287, v0
  v_lshlrev_b32 v148, 1, v148
  v_add_u32 v148, 154816, v148
  ds_read_u16 v149, v148
  ds_read_u16 v150, v148 offset:576
  ds_read_u16 v151, v148 offset:1152
  v_cmp_gt_u32 vcc, 288, v0
  s_and_saveexec_b64 s[54:55], vcc
  ds_write_b32 v135, v134
  s_mov_b64 exec, -1
  s_waitcnt lgkmcnt(0)
  v_lshlrev_b32 v149, 16, v149
  v_lshlrev_b32 v150, 16, v150
  v_lshlrev_b32 v151, 16, v151
  s_mov_b32 s48, 0xc0135761
  s_mov_b32 s49, 0xbdd2d3e8
  v_mul_f32 v158, v150, v150
  v_mul_f32 v153, v149, v149
  v_mul_f32 v152, v153, v149
  v_mul_f32 v152, s49, v152
  v_mul_f32 v153, v153, v150
  v_mov_b32 v154, s48
  v_mov_b32 v155, s48
  v_fmac_f32 v155, s49, v158
  s_mov_b32 s49, 0xbe9e1eee
  v_mul_f32 v153, s49, v153
  v_fmac_f32 v154, s49, v158
  v_mul_f32 v154, v154, v149
  v_mul_f32 v155, v155, v150
  v_mul_f32 v156, v149, v151
  v_mul_f32 v157, v150, v151
  v_cvt_pk_bf16_f32 v160, v152, v152
  v_and_b32 v160, 0xffff0000, v160
  v_sub_f32 v161, v152, v160
  v_cvt_pk_bf16_f32 v162, v153, v153
  v_and_b32 v162, 0xffff0000, v162
  v_sub_f32 v163, v153, v162
  v_cvt_pk_bf16_f32 v244, v160, v161
  v_cvt_pk_bf16_f32 v245, v160, v162
  v_cvt_pk_bf16_f32 v246, v163, v162
  v_cvt_pk_bf16_f32 v160, v154, v154
  v_and_b32 v160, 0xffff0000, v160
  v_sub_f32 v161, v154, v160
  v_cvt_pk_bf16_f32 v247, v160, v161
  v_cvt_pk_bf16_f32 v160, v155, v155
  v_and_b32 v160, 0xffff0000, v160
  v_sub_f32 v161, v155, v160
  v_cvt_pk_bf16_f32 v248, v160, v161
  v_cvt_pk_bf16_f32 v160, v156, v156
  v_and_b32 v160, 0xffff0000, v160
  v_sub_f32 v161, v156, v160
  v_cvt_pk_bf16_f32 v249, v160, v161
  v_cvt_pk_bf16_f32 v160, v157, v157
  v_and_b32 v160, 0xffff0000, v160
  v_sub_f32 v161, v157, v160
  v_cvt_pk_bf16_f32 v250, v160, v161
  v_mov_b32 v251, 0
L_su_5:
  s_waitcnt vmcnt(4)
  s_barrier
  s_mov_b32 s44, s12
  s_and_b32 s45, s13, 0xffff
  s_mov_b32 s46, 4194304
  s_mov_b32 s47, 0x00020000
  s_lshl_b32 s48, s40, 20
  s_lshr_b32 s49, s36, 1
  s_lshl_b32 s49, s49, 16
  s_add_u32 s48, s48, s49
  s_lshl_b32 s49, s39, 8
  s_add_u32 s48, s48, s49
  s_and_b32 s49, s36, 1
  s_lshl_b32 s49, s49, 7
  s_add_u32 s48, s48, s49
  s_lshl_b32 m0, s36, 10
  ds_read_b64_tr_b16 v[48:49], v11 offset:57344
  ds_read_b64_tr_b16 v[50:51], v14 offset:57344
  ds_read_b128 v[60:63], v16 offset:960
  ds_read_b64_tr_b16 v[52:53], v12 offset:0
  ds_read_b64_tr_b16 v[54:55], v15 offset:0
  ds_read_b128 v[64:67], v16 offset:1024
  ds_read_b64_tr_b16 v[56:57], v12 offset:8192
  ds_read_b64_tr_b16 v[58:59], v15 offset:8192
  ds_read_b128 v[68:71], v16 offset:1088
  s_waitcnt lgkmcnt(6)
  v_mfma_f32_16x16x32_bf16 v[72:75], v[48:51], v[60:63], v[72:75]
  s_waitcnt lgkmcnt(3)
  v_mfma_f32_16x16x32_bf16 v[72:75], v[52:55], v[64:67], v[72:75]
  s_waitcnt lgkmcnt(0)
  v_mfma_f32_16x16x32_bf16 v[72:75], v[56:59], v[68:71], v[72:75]
  s_mov_b32 s51, s48
  s_waitcnt lgkmcnt(0)
  s_mul_i32 s35, s34, 0x9e3779b1
  s_add_u32 s35, s35, 0x7f4a7c15
  s_nop 3
  v_cvt_pk_bf16_f32 v76, v72, v73
  v_cvt_pk_bf16_f32 v77, v74, v75
  s_mov_b64 exec, s[58:59]
  ds_write_b64 v17, v[76:77]
  s_mov_b64 exec, -1
  v_mov_b32 v78, 0
  v_mov_b32 v79, s35
  s_mov_b32 s48, 0x3e0293ee
  s_waitcnt vmcnt(0) lgkmcnt(0)
  s_barrier
  ds_read_b128 v[32:35], v20 offset:0
  ds_read_b128 v[80:83], v18 offset:0
  ds_read_b128 v[36:39], v21 offset:0
  ds_read_b128 v[84:87], v18 offset:64
  ds_read_b128 v[40:43], v20 offset:1024
  ds_read_b128 v[88:91], v18 offset:128
  ds_read_b128 v[44:47], v21 offset:1024
  ds_read_b128 v[92:95], v18 offset:192
  s_waitcnt lgkmcnt(6)
  v_mfma_f32_16x16x32_bf16 v[72:75], v[32:35], v[80:83], 0
  s_waitcnt lgkmcnt(4)
  v_mfma_f32_16x16x32_bf16 v[72:75], v[36:39], v[84:87], v[72:75]
  s_waitcnt lgkmcnt(2)
  v_mfma_f32_16x16x32_bf16 v[72:75], v[40:43], v[88:91], v[72:75]
  s_waitcnt lgkmcnt(0)
  v_mfma_f32_16x16x32_bf16 v[72:75], v[44:47], v[92:95], v[72:75]
  s_nop 7
  v_mul_f32 v72, s48, v72
  v_mul_f32 v73, s48, v73
  v_mul_f32 v74, s48, v74
  v_mul_f32 v75, s48, v75
  v_cvt_pk_bf16_f32 v76, v72, v73
  v_cvt_pk_bf16_f32 v77, v74, v75
  s_mov_b64 exec, s[58:59]
  global_store_dwordx4 v19, v[76:79], s[32:33] sc1
  s_mov_b64 exec, -1
  buffer_load_dwordx4 v4, s[44:47], s51 offen lds
  s_add_u32 s51, s51, 262144
  s_add_u32 m0, m0, 8192
  s_nop 0
  buffer_load_dwordx4 v4, s[44:47], s51 offen lds
  s_add_u32 s51, s51, 262144
  s_add_u32 m0, m0, 8192
  s_nop 0
  buffer_load_dwordx4 v4, s[44:47], s51 offen lds
  s_add_u32 s51, s51, 262144
  s_add_u32 m0, m0, 8192
  s_nop 0
  buffer_load_dwordx4 v4, s[44:47], s51 offen lds
  s_lshr_b32 s60, s41, 4
  s_and_b32 s61, s41, 15
  s_lshr_b32 s63, s60, 1
  s_waitcnt lgkmcnt(0)
  s_barrier
  v_lshlrev_b32 v5, 5, v0
  v_add_u32 v5, 147456, v5
  v_cmp_gt_u32 vcc, 288, v0
  s_and_saveexec_b64 s[54:55], vcc
  ds_write_b128 v5, v[244:247]
  ds_write_b128 v5, v[248:251] offset:16
  s_mov_b64 exec, -1
  s_lshl_b32 s48, s63, 4
  s_add_u32 s48, s48, 162944
  v_mov_b32 v12, s48
  ds_read_b128 v[234:237], v12
  v_lshrrev_b32 v10, 3, v1
  v_and_b32 v11, 6, v10
  v_and_b32 v28, 7, v1
  v_xor_b32 v11, v11, v28
  v_lshlrev_b32 v11, 4, v11
  v_mul_u32_u24 v10, 1152, v10
  v_add_u32 v28, v10, v11
  s_and_b32 s48, s36, 3
  v_and_b32 v10, 1, v3
  v_lshlrev_b32 v10, 2, v10
  v_lshrrev_b32 v11, 2, v2
  v_add_u32 v10, v10, v11
  v_bfe_u32 v11, v2, 1, 1
  v_lshl_add_u32 v11, s48, 1, v11
  v_and_b32 v9, 6, v10
  v_xor_b32 v11, v11, v9
  v_lshlrev_b32 v11, 4, v11
  v_lshl_add_u32 v11, v10, 7, v11
  v_and_b32 v10, 1, v2
  v_lshl_add_u32 v11, v10, 3, v11
  v_lshrrev_b32 v10, 1, v3
  v_mul_u32_u24 v10, 2048, v10
  v_add_u32 v9, v10, v11
  s_lshr_b32 s48, s36, 2
  s_lshl_b32 s48, s48, 10
  v_add_u32 v9, s48, v9
  v_mov_b32 v29, v9
  s_waitcnt lgkmcnt(0)
  s_barrier
  s_cmp_lg_u32 s36, 7
  s_cbranch_scc1 L_mlp_6
  s_mov_b32 s44, s14
  s_and_b32 s45, s15, 0xffff
  s_mov_b32 s46, 4718592
  s_mov_b32 s47, 0x00020000
  s_mul_i32 s50, s40, 3
  s_mul_i32 s49, s39, 147456
  s_mov_b32 s51, 5
L_wo_8:
  s_add_u32 s48, s50, 4
  s_mul_i32 s48, s48, 9216
  s_mov_b32 m0, s48
  s_add_u32 s48, s48, s49
  buffer_load_dwordx4 v28, s[44:47], s48 offen lds
  s_add_u32 s48, s48, 128
  s_add_u32 m0, m0, 1024
  s_nop 0
  buffer_load_dwordx4 v28, s[44:47], s48 offen lds
  s_add_u32 s48, s48, 128
  s_add_u32 m0, m0, 1024
  s_nop 0
  buffer_load_dwordx4 v28, s[44:47], s48 offen lds
  s_add_u32 s48, s48, 128
  s_add_u32 m0, m0, 1024
  s_nop 0
  buffer_load_dwordx4 v28, s[44:47], s48 offen lds
  s_add_u32 s48, s48, 128
  s_add_u32 m0, m0, 1024
  s_nop 0
  buffer_load_dwordx4 v28, s[44:47], s48 offen lds
  s_add_u32 s48, s48, 128
  s_add_u32 m0, m0, 1024
  s_nop 0
  buffer_load_dwordx4 v28, s[44:47], s48 offen lds
  s_add_u32 s48, s48, 128
  s_add_u32 m0, m0, 1024
  s_nop 0
  buffer_load_dwordx4 v28, s[44:47], s48 offen lds
  s_add_u32 s48, s48, 128
  s_add_u32 m0, m0, 1024
  s_nop 0
  buffer_load_dwordx4 v28, s[44:47], s48 offen lds
  s_add_u32 s48, s48, 128
  s_add_u32 m0, m0, 1024
  s_nop 0
  buffer_load_dwordx4 v28, s[44:47], s48 offen lds
  s_add_u32 s50, s50, 1
  s_cmp_eq_u32 s50, 12
  s_cselect_b32 s50, 0, s50
  s_sub_u32 s51, s51, 1
  s_cmp_lg_u32 s51, 0
  s_cbranch_scc1 L_wo_8
  s_waitcnt vmcnt(45)
  s_barrier
  ds_read_b64_tr_b16 v[32:33], v29 offset:0
  ds_read_b64_tr_b16 v[34:35], v29 offset:4096
  ds_read_b64_tr_b16 v[36:37], v29 offset:8192
  ds_read_b64_tr_b16 v[38:39], v29 offset:12288
  ds_read_b64_tr_b16 v[40:41], v29 offset:16384
  ds_read_b64_tr_b16 v[42:43], v29 offset:20480
  ds_read_b64_tr_b16 v[44:45], v29 offset:24576
  ds_read_b64_tr_b16 v[46:47], v29 offset:28672
  s_waitcnt lgkmcnt(0)
  s_barrier
  s_mov_b32 s51, 7
L_wo_9:
  s_add_u32 s48, s50, 4
  s_mul_i32 s48, s48, 9216
  s_mov_b32 m0, s48
  s_add_u32 s48, s48, s49
  buffer_load_dwordx4 v28, s[44:47], s48 offen lds
  s_add_u32 s48, s48, 128
  s_add_u32 m0, m0, 1024
  s_nop 0
  buffer_load_dwordx4 v28, s[44:47], s48 offen lds
  s_add_u32 s48, s48, 128
  s_add_u32 m0, m0, 1024
  s_nop 0
  buffer_load_dwordx4 v28, s[44:47], s48 offen lds
  s_add_u32 s48, s48, 128
  s_add_u32 m0, m0, 1024
  s_nop 0
  buffer_load_dwordx4 v28, s[44:47], s48 offen lds
  s_add_u32 s48, s48, 128
  s_add_u32 m0, m0, 1024
  s_nop 0
  buffer_load_dwordx4 v28, s[44:47], s48 offen lds
  s_add_u32 s48, s48, 128
  s_add_u32 m0, m0, 1024
  s_nop 0
  buffer_load_dwordx4 v28, s[44:47], s48 offen lds
  s_add_u32 s48, s48, 128
  s_add_u32 m0, m0, 1024
  s_nop 0
  buffer_load_dwordx4 v28, s[44:47], s48 offen lds
  s_add_u32 s48, s48, 128
  s_add_u32 m0, m0, 1024
  s_nop 0
  buffer_load_dwordx4 v28, s[44:47], s48 offen lds
  s_add_u32 s48, s48, 128
  s_add_u32 m0, m0, 1024
  s_nop 0
  buffer_load_dwordx4 v28, s[44:47], s48 offen lds
  s_add_u32 s50, s50, 1
  s_cmp_eq_u32 s50, 12
  s_cselect_b32 s50, 0, s50
  s_sub_u32 s51, s51, 1
  s_cmp_lg_u32 s51, 0
  s_cbranch_scc1 L_wo_9
  s_mov_b32 s50, s40
  s_mov_b32 s51, 4
L_wo_10:
  s_add_u32 s48, s50, 0
  s_mul_i32 s48, s48, 9216
  s_mov_b32 m0, s48
  s_add_u32 s48, s48, s49
  buffer_load_dwordx4 v28, s[44:47], s48 offen lds
  s_add_u32 s48, s48, 128
  s_add_u32 m0, m0, 1024
  s_nop 0
  buffer_load_dwordx4 v28, s[44:47], s48 offen lds
  s_add_u32 s48, s48, 128
  s_add_u32 m0, m0, 1024
  s_nop 0
  buffer_load_dwordx4 v28, s[44:47], s48 offen lds
  s_add_u32 s48, s48, 128
  s_add_u32 m0, m0, 1024
  s_nop 0
  buffer_load_dwordx4 v28, s[44:47], s48 offen lds
  s_add_u32 s48, s48, 128
  s_add_u32 m0, m0, 1024
  s_nop 0
  buffer_load_dwordx4 v28, s[44:47], s48 offen lds
  s_add_u32 s48, s48, 128
  s_add_u32 m0, m0, 1024
  s_nop 0
  buffer_load_dwordx4 v28, s[44:47], s48 offen lds
  s_add_u32 s48, s48, 128
  s_add_u32 m0, m0, 1024
  s_nop 0
  buffer_load_dwordx4 v28, s[44:47], s48 offen lds
  s_add_u32 s48, s48, 128
  s_add_u32 m0, m0, 1024
  s_nop 0
  buffer_load_dwordx4 v28, s[44:47], s48 offen lds
  s_add_u32 s48, s48, 128
  s_add_u32 m0, m0, 1024
  s_nop 0
  buffer_load_dwordx4 v28, s[44:47], s48 offen lds
  s_add_u32 s50, s50, 1
  s_cmp_eq_u32 s50, 4
  s_cselect_b32 s50, 0, s50
  s_sub_u32 s51, s51, 1
  s_cmp_lg_u32 s51, 0
  s_cbranch_scc1 L_wo_10
  s_branch L_mlpend_7
L_mlp_6:
  s_and_b32 s48, s60, 1
  s_mul_i32 s48, s48, 576
  s_mul_i32 s51, s63, 1152
  s_add_u32 s51, s51, s48
  s_add_u32 s51, s51, 156672
  v_and_b32 v12, 31, v1
  v_lshlrev_b32 v12, 5, v12
  v_lshrrev_b32 v13, 5, v1
  v_lshl_add_u32 v12, v13, 4, v12
  v_add_u32 v12, 147456, v12
  s_cmp_eq_u32 s36, 3
  s_cbranch_scc1 L_w3_11
  s_sub_u32 s48, s36, 1
  s_cmp_ge_u32 s36, 4
  s_cselect_b32 s50, s48, s36
  s_lshl_b32 s49, s50, 6
  s_add_u32 s48, s51, s49
  v_and_b32 v13, 31, v1
  v_lshl_add_u32 v13, v13, 1, s48
  ds_read_u16 v14, v13
  s_waitcnt lgkmcnt(0)
  v_lshlrev_b32 v14, 16, v14
  v_sub_f32 v14, v14, v235
  v_mul_f32 v14, v14, v236
  v_cvt_pk_bf16_f32 v14, v14, v14
  v_and_b32 v15, 0xffff0000, v14
  v_mul_f32 v16, v15, v15
  v_mul_f32 v17, v16, v15
  v_cvt_pk_bf16_f32 v18, v16, v16
  v_and_b32 v18, 0xffff0000, v18
  v_sub_f32 v19, v16, v18
  v_cvt_pk_bf16_f32 v20, v17, v17
  v_and_b32 v20, 0xffff0000, v20
  v_sub_f32 v21, v17, v20
  v_cvt_pk_bf16_f32 v192, v20, v20
  v_cvt_pk_bf16_f32 v193, v21, v18
  v_cvt_pk_bf16_f32 v194, v18, v19
  v_mov_b32 v195, v14
  v_cmp_gt_u32 vcc, 32, v1
  v_mov_b32 v22, 0x3f803f80
  s_nop 0
  v_cndmask_b32 v192, v22, v192, vcc
  v_cndmask_b32 v193, 0, v193, vcc
  v_cndmask_b32 v194, 0, v194, vcc
  v_cndmask_b32 v195, 0, v195, vcc
  v_mov_b32 v196, 0
  v_cndmask_b32 v197, v14, 0, vcc
  v_cndmask_b32 v198, v22, 0, vcc
  v_mov_b32 v199, 0
  v_mov_b32 v208, 0
  v_mov_b32 v209, 0
  v_mov_b32 v210, 0
  v_mov_b32 v211, 0
  ds_read_b128 v[200:203], v12 offset:0
  s_waitcnt lgkmcnt(0)
  v_mfma_f32_32x32x16_bf16 v[128:143], v[200:203], v[192:195], 0
  v_mfma_f32_32x32x16_bf16 v[144:159], v[200:203], v[196:199], 0
  ds_read_b128 v[204:207], v12 offset:1024
  s_waitcnt lgkmcnt(0)
  v_mfma_f32_32x32x16_bf16 v[160:175], v[204:207], v[192:195], 0
  v_mfma_f32_32x32x16_bf16 v[176:191], v[204:207], v[196:199], 0
  s_nop 6
  v_exp_f32 v128, v128
  v_exp_f32 v129, v129
  v_exp_f32 v130, v130
  v_exp_f32 v131, v131
  v_exp_f32 v132, v132
  v_exp_f32 v133, v133
  v_exp_f32 v134, v134
  v_exp_f32 v135, v135
  v_exp_f32 v136, v136
  v_exp_f32 v137, v137
  v_exp_f32 v138, v138
  v_exp_f32 v139, v139
  v_exp_f32 v140, v140
  v_exp_f32 v141, v141
  v_exp_f32 v142, v142
  v_exp_f32 v143, v143
  v_pk_add_f32 v[128:129], v[128:129], 1.0 op_sel_hi:[1,0]
  v_pk_add_f32 v[130:131], v[130:131], 1.0 op_sel_hi:[1,0]
  v_pk_add_f32 v[132:133], v[132:133], 1.0 op_sel_hi:[1,0]
  v_pk_add_f32 v[134:135], v[134:135], 1.0 op_sel_hi:[1,0]
  v_pk_add_f32 v[136:137], v[136:137], 1.0 op_sel_hi:[1,0]
  v_pk_add_f32 v[138:139], v[138:139], 1.0 op_sel_hi:[1,0]
  v_pk_add_f32 v[140:141], v[140:141], 1.0 op_sel_hi:[1,0]
  v_pk_add_f32 v[142:143], v[142:143], 1.0 op_sel_hi:[1,0]
  ds_read_b128 v[200:203], v12 offset:2048
  v_rcp_f32 v128, v128
  v_rcp_f32 v129, v129
  v_rcp_f32 v130, v130
  v_rcp_f32 v131, v131
  v_rcp_f32 v132, v132
  v_rcp_f32 v133, v133
  v_rcp_f32 v134, v134
  v_rcp_f32 v135, v135
  v_rcp_f32 v136, v136
  v_rcp_f32 v137, v137
  v_rcp_f32 v138, v138
  v_rcp_f32 v139, v139
  v_rcp_f32 v140, v140
  v_rcp_f32 v141, v141
  v_rcp_f32 v142, v142
  v_rcp_f32 v143, v143
  v_pk_fma_f32 v[208:209], v[144:145], v[128:129], v[208:209]
  v_pk_fma_f32 v[210:211], v[146:147], v[130:131], v[210:211]
  v_pk_fma_f32 v[208:209], v[148:149], v[132:133], v[208:209]
  v_pk_fma_f32 v[210:211], v[150:151], v[134:135], v[210:211]
  v_pk_fma_f32 v[208:209], v[152:153], v[136:137], v[208:209]
  v_pk_fma_f32 v[210:211], v[154:155], v[138:139], v[210:211]
  v_pk_fma_f32 v[208:209], v[156:157], v[140:141], v[208:209]
  v_pk_fma_f32 v[210:211], v[158:159], v[142:143], v[210:211]
  s_waitcnt lgkmcnt(0)
  v_mfma_f32_32x32x16_bf16 v[128:143], v[200:203], v[192:195], 0
  v_mfma_f32_32x32x16_bf16 v[144:159], v[200:203], v[196:199], 0
  v_exp_f32 v160, v160
  v_exp_f32 v161, v161
  v_exp_f32 v162, v162
  v_exp_f32 v163, v163
  v_exp_f32 v164, v164
  v_exp_f32 v165, v165
  v_exp_f32 v166, v166
  v_exp_f32 v167, v167
  v_exp_f32 v168, v168
  v_exp_f32 v169, v169
  v_exp_f32 v170, v170
  v_exp_f32 v171, v171
  v_exp_f32 v172, v172
  v_exp_f32 v173, v173
  v_exp_f32 v174, v174
  v_exp_f32 v175, v175
  v_pk_add_f32 v[160:161], v[160:161], 1.0 op_sel_hi:[1,0]
  v_pk_add_f32 v[162:163], v[162:163], 1.0 op_sel_hi:[1,0]
  v_pk_add_f32 v[164:165], v[164:165], 1.0 op_sel_hi:[1,0]
  v_pk_add_f32 v[166:167], v[166:167], 1.0 op_sel_hi:[1,0]
  v_pk_add_f32 v[168:169], v[168:169], 1.0 op_sel_hi:[1,0]
  v_pk_add_f32 v[170:171], v[170:171], 1.0 op_sel_hi:[1,0]
  v_pk_add_f32 v[172:173], v[172:173], 1.0 op_sel_hi:[1,0]
  v_pk_add_f32 v[174:175], v[174:175], 1.0 op_sel_hi:[1,0]
  ds_read_b128 v[204:207], v12 offset:3072
  v_rcp_f32 v160, v160
  v_rcp_f32 v161, v161
  v_rcp_f32 v162, v162
  v_rcp_f32 v163, v163
  v_rcp_f32 v164, v164
  v_rcp_f32 v165, v165
  v_rcp_f32 v166, v166
  v_rcp_f32 v167, v167
  v_rcp_f32 v168, v168
  v_rcp_f32 v169, v169
  v_rcp_f32 v170, v170
  v_rcp_f32 v171, v171
  v_rcp_f32 v172, v172
  v_rcp_f32 v173, v173
  v_rcp_f32 v174, v174
  v_rcp_f32 v175, v175
  v_pk_fma_f32 v[208:209], v[176:177], v[160:161], v[208:209]
  v_pk_fma_f32 v[210:211], v[178:179], v[162:163], v[210:211]
  v_pk_fma_f32 v[208:209], v[180:181], v[164:165], v[208:209]
  v_pk_fma_f32 v[210:211], v[182:183], v[166:167], v[210:211]
  v_pk_fma_f32 v[208:209], v[184:185], v[168:169], v[208:209]
  v_pk_fma_f32 v[210:211], v[186:187], v[170:171], v[210:211]
  v_pk_fma_f32 v[208:209], v[188:189], v[172:173], v[208:209]
  v_pk_fma_f32 v[210:211], v[190:191], v[174:175], v[210:211]
  s_waitcnt lgkmcnt(0)
  v_mfma_f32_32x32x16_bf16 v[160:175], v[204:207], v[192:195], 0
  v_mfma_f32_32x32x16_bf16 v[176:191], v[204:207], v[196:199], 0
  v_exp_f32 v128, v128
  v_exp_f32 v129, v129
  v_exp_f32 v130, v130
  v_exp_f32 v131, v131
  v_exp_f32 v132, v132
  v_exp_f32 v133, v133
  v_exp_f32 v134, v134
  v_exp_f32 v135, v135
  v_exp_f32 v136, v136
  v_exp_f32 v137, v137
  v_exp_f32 v138, v138
  v_exp_f32 v139, v139
  v_exp_f32 v140, v140
  v_exp_f32 v141, v141
  v_exp_f32 v142, v142
  v_exp_f32 v143, v143
  v_pk_add_f32 v[128:129], v[128:129], 1.0 op_sel_hi:[1,0]
  v_pk_add_f32 v[130:131], v[130:131], 1.0 op_sel_hi:[1,0]
  v_pk_add_f32 v[132:133], v[132:133], 1.0 op_sel_hi:[1,0]
  v_pk_add_f32 v[134:135], v[134:135], 1.0 op_sel_hi:[1,0]
  v_pk_add_f32 v[136:137], v[136:137], 1.0 op_sel_hi:[1,0]
  v_pk_add_f32 v[138:139], v[138:139], 1.0 op_sel_hi:[1,0]
  v_pk_add_f32 v[140:141], v[140:141], 1.0 op_sel_hi:[1,0]
  v_pk_add_f32 v[142:143], v[142:143], 1.0 op_sel_hi:[1,0]
  ds_read_b128 v[200:203], v12 offset:4096
  v_rcp_f32 v128, v128
  v_rcp_f32 v129, v129
  v_rcp_f32 v130, v130
  v_rcp_f32 v131, v131
  v_rcp_f32 v132, v132
  v_rcp_f32 v133, v133
  v_rcp_f32 v134, v134
  v_rcp_f32 v135, v135
  v_rcp_f32 v136, v136
  v_rcp_f32 v137, v137
  v_rcp_f32 v138, v138
  v_rcp_f32 v139, v139
  v_rcp_f32 v140, v140
  v_rcp_f32 v141, v141
  v_rcp_f32 v142, v142
  v_rcp_f32 v143, v143
  v_pk_fma_f32 v[208:209], v[144:145], v[128:129], v[208:209]
  v_pk_fma_f32 v[210:211], v[146:147], v[130:131], v[210:211]
  v_pk_fma_f32 v[208:209], v[148:149], v[132:133], v[208:209]
  v_pk_fma_f32 v[210:211], v[150:151], v[134:135], v[210:211]
  v_pk_fma_f32 v[208:209], v[152:153], v[136:137], v[208:209]
  v_pk_fma_f32 v[210:211], v[154:155], v[138:139], v[210:211]
  v_pk_fma_f32 v[208:209], v[156:157], v[140:141], v[208:209]
  v_pk_fma_f32 v[210:211], v[158:159], v[142:143], v[210:211]
  s_waitcnt vmcnt(0)
  s_barrier
  ds_read_b64_tr_b16 v[32:33], v29 offset:0
  ds_read_b64_tr_b16 v[34:35], v29 offset:4096
  ds_read_b64_tr_b16 v[36:37], v29 offset:8192
  ds_read_b64_tr_b16 v[38:39], v29 offset:12288
  ds_read_b64_tr_b16 v[40:41], v29 offset:16384
  ds_read_b64_tr_b16 v[42:43], v29 offset:20480
  ds_read_b64_tr_b16 v[44:45], v29 offset:24576
  ds_read_b64_tr_b16 v[46:47], v29 offset:28672
  s_waitcnt lgkmcnt(0)
  s_barrier
  s_waitcnt lgkmcnt(0)
  v_mfma_f32_32x32x16_bf16 v[128:143], v[200:203], v[192:195], 0
  v_mfma_f32_32x32x16_bf16 v[144:159], v[200:203], v[196:199], 0
  v_exp_f32 v160, v160
  v_exp_f32 v161, v161
  v_exp_f32 v162, v162
  v_exp_f32 v163, v163
  v_exp_f32 v164, v164
  v_exp_f32 v165, v165
  v_exp_f32 v166, v166
  v_exp_f32 v167, v167
  v_exp_f32 v168, v168
  v_exp_f32 v169, v169
  v_exp_f32 v170, v170
  v_exp_f32 v171, v171
  v_exp_f32 v172, v172
  v_exp_f32 v173, v173
  v_exp_f32 v174, v174
  v_exp_f32 v175, v175
  v_pk_add_f32 v[160:161], v[160:161], 1.0 op_sel_hi:[1,0]
  v_pk_add_f32 v[162:163], v[162:163], 1.0 op_sel_hi:[1,0]
  v_pk_add_f32 v[164:165], v[164:165], 1.0 op_sel_hi:[1,0]
  v_pk_add_f32 v[166:167], v[166:167], 1.0 op_sel_hi:[1,0]
  v_pk_add_f32 v[168:169], v[168:169], 1.0 op_sel_hi:[1,0]
  v_pk_add_f32 v[170:171], v[170:171], 1.0 op_sel_hi:[1,0]
  v_pk_add_f32 v[172:173], v[172:173], 1.0 op_sel_hi:[1,0]
  v_pk_add_f32 v[174:175], v[174:175], 1.0 op_sel_hi:[1,0]
  ds_read_b128 v[204:207], v12 offset:5120
  v_rcp_f32 v160, v160
  v_rcp_f32 v161, v161
  v_rcp_f32 v162, v162
  v_rcp_f32 v163, v163
  v_rcp_f32 v164, v164
  v_rcp_f32 v165, v165
  v_rcp_f32 v166, v166
  v_rcp_f32 v167, v167
  v_rcp_f32 v168, v168
  v_rcp_f32 v169, v169
  v_rcp_f32 v170, v170
  v_rcp_f32 v171, v171
  v_rcp_f32 v172, v172
  v_rcp_f32 v173, v173
  v_rcp_f32 v174, v174
  v_rcp_f32 v175, v175
  v_pk_fma_f32 v[208:209], v[176:177], v[160:161], v[208:209]
  v_pk_fma_f32 v[210:211], v[178:179], v[162:163], v[210:211]
  v_pk_fma_f32 v[208:209], v[180:181], v[164:165], v[208:209]
  v_pk_fma_f32 v[210:211], v[182:183], v[166:167], v[210:211]
  v_pk_fma_f32 v[208:209], v[184:185], v[168:169], v[208:209]
  v_pk_fma_f32 v[210:211], v[186:187], v[170:171], v[210:211]
  v_pk_fma_f32 v[208:209], v[188:189], v[172:173], v[208:209]
  v_pk_fma_f32 v[210:211], v[190:191], v[174:175], v[210:211]
  s_waitcnt lgkmcnt(0)
  v_mfma_f32_32x32x16_bf16 v[160:175], v[204:207], v[192:195], 0
  v_mfma_f32_32x32x16_bf16 v[176:191], v[204:207], v[196:199], 0
  v_exp_f32 v128, v128
  v_exp_f32 v129, v129
  v_exp_f32 v130, v130
  v_exp_f32 v131, v131
  v_exp_f32 v132, v132
  v_exp_f32 v133, v133
  v_exp_f32 v134, v134
  v_exp_f32 v135, v135
  v_exp_f32 v136, v136
  v_exp_f32 v137, v137
  v_exp_f32 v138, v138
  v_exp_f32 v139, v139
  v_exp_f32 v140, v140
  v_exp_f32 v141, v141
  v_exp_f32 v142, v142
  v_exp_f32 v143, v143
  v_pk_add_f32 v[128:129], v[128:129], 1.0 op_sel_hi:[1,0]
  v_pk_add_f32 v[130:131], v[130:131], 1.0 op_sel_hi:[1,0]
  v_pk_add_f32 v[132:133], v[132:133], 1.0 op_sel_hi:[1,0]
  v_pk_add_f32 v[134:135], v[134:135], 1.0 op_sel_hi:[1,0]
  v_pk_add_f32 v[136:137], v[136:137], 1.0 op_sel_hi:[1,0]
  v_pk_add_f32 v[138:139], v[138:139], 1.0 op_sel_hi:[1,0]
  v_pk_add_f32 v[140:141], v[140:141], 1.0 op_sel_hi:[1,0]
  v_pk_add_f32 v[142:143], v[142:143], 1.0 op_sel_hi:[1,0]
  ds_read_b128 v[200:203], v12 offset:6144
  v_rcp_f32 v128, v128
  v_rcp_f32 v129, v129
  v_rcp_f32 v130, v130
  v_rcp_f32 v131, v131
  v_rcp_f32 v132, v132
  v_rcp_f32 v133, v133
  v_rcp_f32 v134, v134
  v_rcp_f32 v135, v135
  v_rcp_f32 v136, v136
  v_rcp_f32 v137, v137
  v_rcp_f32 v138, v138
  v_rcp_f32 v139, v139
  v_rcp_f32 v140, v140
  v_rcp_f32 v141, v141
  v_rcp_f32 v142, v142
  v_rcp_f32 v143, v143
  v_pk_fma_f32 v[208:209], v[144:145], v[128:129], v[208:209]
  v_pk_fma_f32 v[210:211], v[146:147], v[130:131], v[210:211]
  v_pk_fma_f32 v[208:209], v[148:149], v[132:133], v[208:209]
  v_pk_fma_f32 v[210:211], v[150:151], v[134:135], v[210:211]
  v_pk_fma_f32 v[208:209], v[152:153], v[136:137], v[208:209]
  v_pk_fma_f32 v[210:211], v[154:155], v[138:139], v[210:211]
  v_pk_fma_f32 v[208:209], v[156:157], v[140:141], v[208:209]
  v_pk_fma_f32 v[210:211], v[158:159], v[142:143], v[210:211]
  s_waitcnt lgkmcnt(0)
  v_mfma_f32_32x32x16_bf16 v[128:143], v[200:203], v[192:195], 0
  v_mfma_f32_32x32x16_bf16 v[144:159], v[200:203], v[196:199], 0
  v_exp_f32 v160, v160
  v_exp_f32 v161, v161
  v_exp_f32 v162, v162
  v_exp_f32 v163, v163
  v_exp_f32 v164, v164
  v_exp_f32 v165, v165
  v_exp_f32 v166, v166
  v_exp_f32 v167, v167
  v_exp_f32 v168, v168
  v_exp_f32 v169, v169
  v_exp_f32 v170, v170
  v_exp_f32 v171, v171
  v_exp_f32 v172, v172
  v_exp_f32 v173, v173
  v_exp_f32 v174, v174
  v_exp_f32 v175, v175
  v_pk_add_f32 v[160:161], v[160:161], 1.0 op_sel_hi:[1,0]
  v_pk_add_f32 v[162:163], v[162:163], 1.0 op_sel_hi:[1,0]
  v_pk_add_f32 v[164:165], v[164:165], 1.0 op_sel_hi:[1,0]
  v_pk_add_f32 v[166:167], v[166:167], 1.0 op_sel_hi:[1,0]
  v_pk_add_f32 v[168:169], v[168:169], 1.0 op_sel_hi:[1,0]
  v_pk_add_f32 v[170:171], v[170:171], 1.0 op_sel_hi:[1,0]
  v_pk_add_f32 v[172:173], v[172:173], 1.0 op_sel_hi:[1,0]
  v_pk_add_f32 v[174:175], v[174:175], 1.0 op_sel_hi:[1,0]
  ds_read_b128 v[204:207], v12 offset:7168
  v_rcp_f32 v160, v160
  v_rcp_f32 v161, v161
  v_rcp_f32 v162, v162
  v_rcp_f32 v163, v163
  v_rcp_f32 v164, v164
  v_rcp_f32 v165, v165
  v_rcp_f32 v166, v166
  v_rcp_f32 v167, v167
  v_rcp_f32 v168, v168
  v_rcp_f32 v169, v169
  v_rcp_f32 v170, v170
  v_rcp_f32 v171, v171
  v_rcp_f32 v172, v172
  v_rcp_f32 v173, v173
  v_rcp_f32 v174, v174
  v_rcp_f32 v175, v175
  v_pk_fma_f32 v[208:209], v[176:177], v[160:161], v[208:209]
  v_pk_fma_f32 v[210:211], v[178:179], v[162:163], v[210:211]
  v_pk_fma_f32 v[208:209], v[180:181], v[164:165], v[208:209]
  v_pk_fma_f32 v[210:211], v[182:183], v[166:167], v[210:211]
  v_pk_fma_f32 v[208:209], v[184:185], v[168:169], v[208:209]
  v_pk_fma_f32 v[210:211], v[186:187], v[170:171], v[210:211]
  v_pk_fma_f32 v[208:209], v[188:189], v[172:173], v[208:209]
  v_pk_fma_f32 v[210:211], v[190:191], v[174:175], v[210:211]
  s_waitcnt lgkmcnt(0)
  v_mfma_f32_32x32x16_bf16 v[160:175], v[204:207], v[192:195], 0
  v_mfma_f32_32x32x16_bf16 v[176:191], v[204:207], v[196:199], 0
  v_exp_f32 v128, v128
  v_exp_f32 v129, v129
  v_exp_f32 v130, v130
  v_exp_f32 v131, v131
  v_exp_f32 v132, v132
  v_exp_f32 v133, v133
  v_exp_f32 v134, v134
  v_exp_f32 v135, v135
  v_exp_f32 v136, v136
  v_exp_f32 v137, v137
  v_exp_f32 v138, v138
  v_exp_f32 v139, v139
  v_exp_f32 v140, v140
  v_exp_f32 v141, v141
  v_exp_f32 v142, v142
  v_exp_f32 v143, v143
  v_pk_add_f32 v[128:129], v[128:129], 1.0 op_sel_hi:[1,0]
  v_pk_add_f32 v[130:131], v[130:131], 1.0 op_sel_hi:[1,0]
  v_pk_add_f32 v[132:133], v[132:133], 1.0 op_sel_hi:[1,0]
  v_pk_add_f32 v[134:135], v[134:135], 1.0 op_sel_hi:[1,0]
  v_pk_add_f32 v[136:137], v[136:137], 1.0 op_sel_hi:[1,0]
  v_pk_add_f32 v[138:139], v[138:139], 1.0 op_sel_hi:[1,0]
  v_pk_add_f32 v[140:141], v[140:141], 1.0 op_sel_hi:[1,0]
  v_pk_add_f32 v[142:143], v[142:143], 1.0 op_sel_hi:[1,0]
  ds_read_b128 v[200:203], v12 offset:8192
  v_rcp_f32 v128, v128
  v_rcp_f32 v129, v129
  v_rcp_f32 v130, v130
  v_rcp_f32 v131, v131
  v_rcp_f32 v132, v132
  v_rcp_f32 v133, v133
  v_rcp_f32 v134, v134
  v_rcp_f32 v135, v135
  v_rcp_f32 v136, v136
  v_rcp_f32 v137, v137
  v_rcp_f32 v138, v138
  v_rcp_f32 v139, v139
  v_rcp_f32 v140, v140
  v_rcp_f32 v141, v141
  v_rcp_f32 v142, v142
  v_rcp_f32 v143, v143
  v_pk_fma_f32 v[208:209], v[144:145], v[128:129], v[208:209]
  v_pk_fma_f32 v[210:211], v[146:147], v[130:131], v[210:211]
  v_pk_fma_f32 v[208:209], v[148:149], v[132:133], v[208:209]
  v_pk_fma_f32 v[210:211], v[150:151], v[134:135], v[210:211]
  v_pk_fma_f32 v[208:209], v[152:153], v[136:137], v[208:209]
  v_pk_fma_f32 v[210:211], v[154:155], v[138:139], v[210:211]
  v_pk_fma_f32 v[208:209], v[156:157], v[140:141], v[208:209]
  v_pk_fma_f32 v[210:211], v[158:159], v[142:143], v[210:211]
  s_waitcnt lgkmcnt(0)
  v_mfma_f32_32x32x16_bf16 v[128:143], v[200:203], v[192:195], 0
  v_mfma_f32_32x32x16_bf16 v[144:159], v[200:203], v[196:199], 0
  v_exp_f32 v160, v160
  v_exp_f32 v161, v161
  v_exp_f32 v162, v162
  v_exp_f32 v163, v163
  v_exp_f32 v164, v164
  v_exp_f32 v165, v165
  v_exp_f32 v166, v166
  v_exp_f32 v167, v167
  v_exp_f32 v168, v168
  v_exp_f32 v169, v169
  v_exp_f32 v170, v170
  v_exp_f32 v171, v171
  v_exp_f32 v172, v172
  v_exp_f32 v173, v173
  v_exp_f32 v174, v174
  v_exp_f32 v175, v175
  v_pk_add_f32 v[160:161], v[160:161], 1.0 op_sel_hi:[1,0]
  v_pk_add_f32 v[162:163], v[162:163], 1.0 op_sel_hi:[1,0]
  v_pk_add_f32 v[164:165], v[164:165], 1.0 op_sel_hi:[1,0]
  v_pk_add_f32 v[166:167], v[166:167], 1.0 op_sel_hi:[1,0]
  v_pk_add_f32 v[168:169], v[168:169], 1.0 op_sel_hi:[1,0]
  v_pk_add_f32 v[170:171], v[170:171], 1.0 op_sel_hi:[1,0]
  v_pk_add_f32 v[172:173], v[172:173], 1.0 op_sel_hi:[1,0]
  v_pk_add_f32 v[174:175], v[174:175], 1.0 op_sel_hi:[1,0]
  v_rcp_f32 v160, v160
  v_rcp_f32 v161, v161
  v_rcp_f32 v162, v162
  v_rcp_f32 v163, v163
  v_rcp_f32 v164, v164
  v_rcp_f32 v165, v165
  v_rcp_f32 v166, v166
  v_rcp_f32 v167, v167
  v_rcp_f32 v168, v168
  v_rcp_f32 v169, v169
  v_rcp_f32 v170, v170
  v_rcp_f32 v171, v171
  v_rcp_f32 v172, v172
  v_rcp_f32 v173, v173
  v_rcp_f32 v174, v174
  v_rcp_f32 v175, v175
  v_pk_fma_f32 v[208:209], v[176:177], v[160:161], v[208:209]
  v_pk_fma_f32 v[210:211], v[178:179], v[162:163], v[210:211]
  v_pk_fma_f32 v[208:209], v[180:181], v[164:165], v[208:209]
  v_pk_fma_f32 v[210:211], v[182:183], v[166:167], v[210:211]
  v_pk_fma_f32 v[208:209], v[184:185], v[168:169], v[208:209]
  v_pk_fma_f32 v[210:211], v[186:187], v[170:171], v[210:211]
  v_pk_fma_f32 v[208:209], v[188:189], v[172:173], v[208:209]
  v_pk_fma_f32 v[210:211], v[190:191], v[174:175], v[210:211]
  v_exp_f32 v128, v128
  v_exp_f32 v129, v129
  v_exp_f32 v130, v130
  v_exp_f32 v131, v131
  v_exp_f32 v132, v132
  v_exp_f32 v133, v133
  v_exp_f32 v134, v134
  v_exp_f32 v135, v135
  v_exp_f32 v136, v136
  v_exp_f32 v137, v137
  v_exp_f32 v138, v138
  v_exp_f32 v139, v139
  v_exp_f32 v140, v140
  v_exp_f32 v141, v141
  v_exp_f32 v142, v142
  v_exp_f32 v143, v143
  v_pk_add_f32 v[128:129], v[128:129], 1.0 op_sel_hi:[1,0]
  v_pk_add_f32 v[130:131], v[130:131], 1.0 op_sel_hi:[1,0]
  v_pk_add_f32 v[132:133], v[132:133], 1.0 op_sel_hi:[1,0]
  v_pk_add_f32 v[134:135], v[134:135], 1.0 op_sel_hi:[1,0]
  v_pk_add_f32 v[136:137], v[136:137], 1.0 op_sel_hi:[1,0]
  v_pk_add_f32 v[138:139], v[138:139], 1.0 op_sel_hi:[1,0]
  v_pk_add_f32 v[140:141], v[140:141], 1.0 op_sel_hi:[1,0]
  v_pk_add_f32 v[142:143], v[142:143], 1.0 op_sel_hi:[1,0]
  v_rcp_f32 v128, v128
  v_rcp_f32 v129, v129
  v_rcp_f32 v130, v130
  v_rcp_f32 v131, v131
  v_rcp_f32 v132, v132
  v_rcp_f32 v133, v133
  v_rcp_f32 v134, v134
  v_rcp_f32 v135, v135
  v_rcp_f32 v136, v136
  v_rcp_f32 v137, v137
  v_rcp_f32 v138, v138
  v_rcp_f32 v139, v139
  v_rcp_f32 v140, v140
  v_rcp_f32 v141, v141
  v_rcp_f32 v142, v142
  v_rcp_f32 v143, v143
  v_pk_fma_f32 v[208:209], v[144:145], v[128:129], v[208:209]
  v_pk_fma_f32 v[210:211], v[146:147], v[130:131], v[210:211]
  v_pk_fma_f32 v[208:209], v[148:149], v[132:133], v[208:209]
  v_pk_fma_f32 v[210:211], v[150:151], v[134:135], v[210:211]
  v_pk_fma_f32 v[208:209], v[152:153], v[136:137], v[208:209]
  v_pk_fma_f32 v[210:211], v[154:155], v[138:139], v[210:211]
  v_pk_fma_f32 v[208:209], v[156:157], v[140:141], v[208:209]
  v_pk_fma_f32 v[210:211], v[158:159], v[142:143], v[210:211]
L_fl_12:
  v_add_f32 v208, v208, v209
  v_add_f32 v210, v210, v211
  v_add_f32 v208, v208, v210
  v_mov_b32 v209, v208
  v_and_b32 v13, 31, v1
  s_nop 0
  v_permlane32_swap_b32 v208, v209
  v_lshlrev_b32 v13, 2, v13
  s_lshl_b32 s48, s50, 7
  s_add_u32 s48, s48, 161792
  v_add_f32 v208, v208, v209
  v_add_u32 v13, s48, v13
  s_mov_b32 exec_hi, 0
  ds_add_f32 v13, v208
  s_mov_b64 exec, -1
  s_branch L_mlpend_7
L_w3_11:
  s_waitcnt vmcnt(0)
  s_barrier
  ds_read_b64_tr_b16 v[32:33], v29 offset:0
  ds_read_b64_tr_b16 v[34:35], v29 offset:4096
  ds_read_b64_tr_b16 v[36:37], v29 offset:8192
  ds_read_b64_tr_b16 v[38:39], v29 offset:12288
  ds_read_b64_tr_b16 v[40:41], v29 offset:16384
  ds_read_b64_tr_b16 v[42:43], v29 offset:20480
  ds_read_b64_tr_b16 v[44:45], v29 offset:24576
  ds_read_b64_tr_b16 v[46:47], v29 offset:28672
  s_waitcnt lgkmcnt(0)
  s_barrier
L_mlpend_7:
  s_mul_i32 s52, s36, 5
  s_sub_u32 s48, s36, 4
  s_lshl_b32 s48, s48, 2
  s_add_u32 s48, s48, 20
  s_cmp_ge_u32 s36, 4
  s_cselect_b32 s52, s48, s52
  v_and_b32 v13, 1, v3
  v_lshlrev_b32 v13, 2, v13
  v_lshrrev_b32 v14, 2, v2
  v_add_u32 v13, v13, v14
  v_bfe_u32 v14, v2, 1, 1
  v_and_b32 v233, 6, v13
  v_xor_b32 v14, v14, v233
  v_lshlrev_b32 v14, 4, v14
  v_lshl_add_u32 v14, v13, 7, v14
  v_and_b32 v13, 1, v2
  v_lshl_add_u32 v14, v13, 3, v14
  v_lshrrev_b32 v13, 1, v3
  v_mul_u32_u24 v13, 9216, v13
  v_add_u32 v233, v13, v14
  s_add_u32 s48, s52, 0
  s_and_b32 s49, s48, 3
  s_lshl_b32 s49, s49, 5
  s_lshr_b32 s48, s48, 2
  s_lshl_b32 s48, s48, 10
  v_xor_b32 v22, s49, v233
  v_add_u32 v22, s48, v22
  s_add_u32 s48, s52, 1
  s_and_b32 s49, s48, 3
  s_lshl_b32 s49, s49, 5
  s_lshr_b32 s48, s48, 2
  s_lshl_b32 s48, s48, 10
  v_xor_b32 v23, s49, v233
  v_add_u32 v23, s48, v23
  s_add_u32 s48, s52, 2
  s_and_b32 s49, s48, 3
  s_lshl_b32 s49, s49, 5
  s_lshr_b32 s48, s48, 2
  s_lshl_b32 s48, s48, 10
  v_xor_b32 v24, s49, v233
  v_add_u32 v24, s48, v24
  s_add_u32 s48, s52, 3
  s_and_b32 s49, s48, 3
  s_lshl_b32 s49, s49, 5
  s_lshr_b32 s48, s48, 2
  s_lshl_b32 s48, s48, 10
  v_xor_b32 v25, s49, v233
  v_add_u32 v25, s48, v25
  s_add_u32 s48, s52, 4
  s_and_b32 s49, s48, 3
  s_lshl_b32 s49, s49, 5
  s_lshr_b32 s48, s48, 2
  s_lshl_b32 s48, s48, 10
  v_xor_b32 v26, s49, v233
  v_add_u32 v26, s48, v26
  s_waitcnt vmcnt(0) lgkmcnt(0)
  s_barrier
  ds_read_b64_tr_b16 v[48:49], v22 offset:0
  ds_read_b64_tr_b16 v[50:51], v22 offset:18432
  ds_read_b64_tr_b16 v[52:53], v22 offset:36864
  ds_read_b64_tr_b16 v[54:55], v22 offset:55296
  v_add_u32 v13, 65536, v22
  ds_read_b64_tr_b16 v[56:57], v13 offset:8192
  v_add_u32 v13, 65536, v22
  ds_read_b64_tr_b16 v[58:59], v13 offset:26624
  v_add_u32 v13, 65536, v22
  ds_read_b64_tr_b16 v[60:61], v13 offset:45056
  v_add_u32 v13, 65536, v22
  ds_read_b64_tr_b16 v[62:63], v13 offset:63488
  ds_read_b64_tr_b16 v[64:65], v23 offset:0
  ds_read_b64_tr_b16 v[66:67], v23 offset:18432
  ds_read_b64_tr_b16 v[68:69], v23 offset:36864
  ds_read_b64_tr_b16 v[70:71], v23 offset:55296
  v_add_u32 v13, 65536, v23
  ds_read_b64_tr_b16 v[72:73], v13 offset:8192
  v_add_u32 v13, 65536, v23
  ds_read_b64_tr_b16 v[74:75], v13 offset:26624
  v_add_u32 v13, 65536, v23
  ds_read_b64_tr_b16 v[76:77], v13 offset:45056
  v_add_u32 v13, 65536, v23
  ds_read_b64_tr_b16 v[78:79], v13 offset:63488
  ds_read_b64_tr_b16 v[80:81], v24 offset:0
  ds_read_b64_tr_b16 v[82:83], v24 offset:18432
  ds_read_b64_tr_b16 v[84:85], v24 offset:36864
  ds_read_b64_tr_b16 v[86:87], v24 offset:55296
  v_add_u32 v13, 65536, v24
  ds_read_b64_tr_b16 v[88:89], v13 offset:8192
  v_add_u32 v13, 65536, v24
  ds_read_b64_tr_b16 v[90:91], v13 offset:26624
  v_add_u32 v13, 65536, v24
  ds_read_b64_tr_b16 v[92:93], v13 offset:45056
  v_add_u32 v13, 65536, v24
  ds_read_b64_tr_b16 v[94:95], v13 offset:63488
  ds_read_b64_tr_b16 v[96:97], v25 offset:0
  ds_read_b64_tr_b16 v[98:99], v25 offset:18432
  ds_read_b64_tr_b16 v[100:101], v25 offset:36864
  ds_read_b64_tr_b16 v[102:103], v25 offset:55296
  v_add_u32 v13, 65536, v25
  ds_read_b64_tr_b16 v[104:105], v13 offset:8192
  v_add_u32 v13, 65536, v25
  ds_read_b64_tr_b16 v[106:107], v13 offset:26624
  v_add_u32 v13, 65536, v25
  ds_read_b64_tr_b16 v[108:109], v13 offset:45056
  v_add_u32 v13, 65536, v25
  ds_read_b64_tr_b16 v[110:111], v13 offset:63488
  s_cmp_ge_u32 s36, 4
  s_cbranch_scc1 L_wo_17
  ds_read_b64_tr_b16 v[112:113], v26 offset:0
  ds_read_b64_tr_b16 v[114:115], v26 offset:18432
  ds_read_b64_tr_b16 v[116:117], v26 offset:36864
  ds_read_b64_tr_b16 v[118:119], v26 offset:55296
  v_add_u32 v13, 65536, v26
  ds_read_b64_tr_b16 v[120:121], v13 offset:8192
  v_add_u32 v13, 65536, v26
  ds_read_b64_tr_b16 v[122:123], v13 offset:26624
  v_add_u32 v13, 65536, v26
  ds_read_b64_tr_b16 v[124:125], v13 offset:45056
  v_add_u32 v13, 65536, v26
  ds_read_b64_tr_b16 v[126:127], v13 offset:63488
L_wo_17:
  s_lshr_b32 s50, s39, 4
  s_and_b32 s51, s39, 15
  s_mul_i32 s48, s50, 24576
  s_mul_i32 s49, s51, 192
  s_add_u32 s48, s48, s49
  s_mul_i32 s49, s40, 6144
  s_add_u32 s48, s48, s49
  s_add_u32 s48, s48, 790528
  v_lshrrev_b32 v128, 3, v0
  v_and_b32 v129, 7, v0
  v_mul_u32_u24 v130, 49152, v128
  v_add_u32 v130, s48, v130
  v_mul_u32_u24 v240, 49152, v1
  s_add_u32 s48, s48, 3260
  v_add_u32 v240, s48, v240
  v_mul_u32_u24 v131, 288, v128
  v_add_u32 v131, 0, v131
  v_lshlrev_b32 v132, 2, v128
  v_add_u32 v132, 18432, v132
  v_lshlrev_b32 v133, 2, v1
  v_add_u32 v133, 18944, v133
  v_add_u32 v134, 0, v129
  v_cmp_le_u32 vcc, 12, v134
  v_subrev_u32 v135, 12, v134
  s_nop 0
  v_cndmask_b32 v134, v134, v135, vcc
  v_cndmask_b32 v135, 0, 1, vcc
  v_mul_u32_u24 v136, 3072, v135
  v_lshl_add_u32 v136, v134, 4, v136
  v_add_u32 v224, v130, v136
  v_lshrrev_b32 v136, 2, v134
  v_and_b32 v138, 3, v134
  v_lshl_add_u32 v137, v135, 7, v131
  v_lshl_add_u32 v137, v138, 3, v137
  v_lshl_add_u32 v227, v136, 5, v137
  v_lshl_add_u32 v137, v136, 2, v137
  v_add_u32 v137, 96, v137
  v_lshl_add_u32 v135, v135, 2, v138
  v_lshl_add_u32 v138, v135, 8, v132
  v_cmp_gt_u32 vcc, 2, v135
  s_nop 1
  v_cndmask_b32 v138, v133, v138, vcc
  v_cmp_gt_u32 vcc, 2, v136
  s_nop 1
  v_cndmask_b32 v230, v138, v137, vcc
  v_add_u32 v134, 8, v129
  v_cmp_le_u32 vcc, 12, v134
  v_subrev_u32 v135, 12, v134
  s_nop 0
  v_cndmask_b32 v134, v134, v135, vcc
  v_cndmask_b32 v135, 0, 1, vcc
  v_mul_u32_u24 v136, 3072, v135
  v_lshl_add_u32 v136, v134, 4, v136
  v_add_u32 v225, v130, v136
  v_lshrrev_b32 v136, 2, v134
  v_and_b32 v138, 3, v134
  v_lshl_add_u32 v137, v135, 7, v131
  v_lshl_add_u32 v137, v138, 3, v137
  v_lshl_add_u32 v228, v136, 5, v137
  v_lshl_add_u32 v137, v136, 2, v137
  v_add_u32 v137, 96, v137
  v_lshl_add_u32 v135, v135, 2, v138
  v_lshl_add_u32 v138, v135, 8, v132
  v_cmp_gt_u32 vcc, 2, v135
  s_nop 1
  v_cndmask_b32 v138, v133, v138, vcc
  v_cmp_gt_u32 vcc, 2, v136
  s_nop 1
  v_cndmask_b32 v231, v138, v137, vcc
  v_add_u32 v134, 16, v129
  v_cmp_le_u32 vcc, 12, v134
  v_subrev_u32 v135, 12, v134
  s_nop 0
  v_cndmask_b32 v134, v134, v135, vcc
  v_cndmask_b32 v135, 0, 1, vcc
  v_mul_u32_u24 v136, 3072, v135
  v_lshl_add_u32 v136, v134, 4, v136
  v_add_u32 v226, v130, v136
  v_lshrrev_b32 v136, 2, v134
  v_and_b32 v138, 3, v134
  v_lshl_add_u32 v137, v135, 7, v131
  v_lshl_add_u32 v137, v138, 3, v137
  v_lshl_add_u32 v229, v136, 5, v137
  v_lshl_add_u32 v137, v136, 2, v137
  v_add_u32 v137, 96, v137
  v_lshl_add_u32 v135, v135, 2, v138
  v_lshl_add_u32 v138, v135, 8, v132
  v_cmp_gt_u32 vcc, 2, v135
  s_nop 1
  v_cndmask_b32 v138, v133, v138, vcc
  v_cmp_gt_u32 vcc, 2, v136
  s_nop 1
  v_cndmask_b32 v232, v138, v137, vcc
  v_lshrrev_b32 v20, 2, v2
  v_lshl_add_u32 v20, v3, 2, v20
  v_mul_u32_u24 v5, 288, v20
  v_and_b32 v20, 3, v2
  v_lshl_add_u32 v5, v20, 3, v5
  s_lshl_b32 s48, s36, 5
  s_add_u32 s48, s48, 0
  v_add_u32 v5, s48, v5
  v_lshlrev_b32 v6, 6, v20
  v_lshl_add_u32 v6, v3, 4, v6
  v_add_u32 v6, 18432, v6
  s_lshr_b32 s48, s36, 1
  s_lshl_b32 s48, s48, 6
  s_and_b32 s49, s36, 1
  s_lshl_b32 s49, s49, 3
  s_add_u32 s48, s48, s49
  v_mul_u32_u24 v8, 272, v20
  v_lshl_add_u32 v8, v3, 4, v8
  v_add_u32 v7, s48, v8
  v_mul_u32_u24 v9, 2304, v20
  v_lshl_add_u32 v9, v3, 4, v9
  s_lshl_b32 s48, s52, 6
  s_add_u32 s48, s48, 22784
  v_add_u32 v9, s48, v9
  v_lshlrev_b32 v11, 6, v2
  v_lshl_add_u32 v11, v3, 4, v11
  s_mul_i32 s49, s41, 9216
  s_lshl_b32 s48, s52, 8
  s_add_u32 s49, s49, s48
  s_add_u32 s49, s49, 3936256
  v_add_u32 v11, s49, v11
  v_and_b32 v21, 3, v2
  v_lshlrev_b32 v22, 4, v21
  v_add_u32 v22, 162944, v22
  ds_read_b32 v12, v22
  v_lshrrev_b32 v22, 2, v2
  v_cmp_eq_u32 s[84:85], 1, v22
  v_cmp_eq_u32 s[86:87], 2, v22
  v_cmp_eq_u32 s[88:89], 3, v22
  s_cmp_eq_u32 s61, 0
  s_cselect_b32 s49, s53, 0
  s_lshl_b32 s49, s49, 16
  s_and_b32 s48, s60, 1
  s_mul_i32 s48, s48, 18
  s_sub_u32 s48, s52, s48
  s_mov_b32 s50, 0x07060503
  s_mov_b32 s51, 0x07060502
  s_mov_b32 s57, 0x07060501
  s_waitcnt lgkmcnt(0)
  s_barrier
  v_add_u32 v23, s48, v22
  v_cmp_gt_u32 vcc, 18, v23
  v_cmp_eq_u32 s[54:55], s63, v21
  s_and_b64 vcc, vcc, s[54:55]
  v_cndmask_b32 v23, 0, v23, vcc
  v_lshlrev_b32 v23, 6, v23
  v_lshl_add_u32 v23, v3, 4, v23
  v_add_u32 v23, 161792, v23
  ds_read_b128 v[180:183], v23
  v_sub_f32 v24, 1.0, v12
  v_cndmask_b32 v24, 0, v24, vcc
  s_waitcnt lgkmcnt(0)
  v_add_f32 v180, s49, v180
  v_add_f32 v181, s49, v181
  v_add_f32 v182, s49, v182
  v_add_f32 v183, s49, v183
  v_mul_f32 v180, v180, v24
  v_mul_f32 v181, v181, v24
  v_mul_f32 v182, v182, v24
  v_mul_f32 v183, v183, v24
  s_add_u32 s48, s48, 4
  v_mov_b32 v23, s48
  v_cmp_gt_u32 vcc, 18, v23
  v_cmp_eq_u32 s[54:55], s63, v21
  s_and_b64 vcc, vcc, s[54:55]
  v_cndmask_b32 v23, 0, v23, vcc
  v_lshlrev_b32 v23, 6, v23
  v_lshl_add_u32 v23, v3, 4, v23
  v_add_u32 v23, 161792, v23
  ds_read_b128 v[184:187], v23
  v_sub_f32 v24, 1.0, v12
  v_cndmask_b32 v24, 0, v24, vcc
  s_waitcnt lgkmcnt(0)
  v_add_f32 v184, s49, v184
  v_add_f32 v185, s49, v185
  v_add_f32 v186, s49, v186
  v_add_f32 v187, s49, v187
  v_mul_f32 v184, v184, v24
  v_mul_f32 v185, v185, v24
  v_mul_f32 v186, v186, v24
  v_mul_f32 v187, v187, v24
  v_cmp_eq_u32 s[12:13], 0, v2
  v_cmp_eq_u32 s[14:15], 1, v2
  v_cmp_eq_u32 s[16:17], 2, v2
  v_cmp_eq_u32 s[18:19], 3, v2
  s_mov_b32 s56, 0
L_hp_18:
  global_load_dwordx4 v[212:215], v224, s[32:33] sc1
  global_load_dwordx4 v[216:219], v225, s[32:33] sc1
  global_load_dwordx4 v[220:223], v226, s[32:33] sc1
  s_waitcnt vmcnt(0)
  v_cmp_eq_u32 s[54:55], s35, v215
  v_cmp_eq_u32 vcc, s35, v219
  s_and_b64 s[54:55], s[54:55], vcc
  v_cmp_eq_u32 vcc, s35, v223
  s_and_b64 s[54:55], s[54:55], vcc
  s_cmp_eq_u64 s[54:55], -1
  s_cbranch_scc1 L_hd_20
L_hs_19:
  s_add_u32 s56, s56, 1
  s_cmp_ge_u32 s56, 200000
  s_cbranch_scc1 L_hd_20
  s_sleep 2
  global_load_dwordx4 v[220:223], v226, s[32:33] sc1
  s_waitcnt vmcnt(0)
  v_cmp_eq_u32 s[54:55], s35, v223
  s_cmp_eq_u64 s[54:55], -1
  s_cbranch_scc1 L_hp_18
  s_branch L_hs_19
L_hd_20:
  ds_write_b64 v227, v[212:213]
  ds_write_b32 v230, v214
  ds_write_b64 v228, v[216:217]
  ds_write_b32 v231, v218
  ds_write_b64 v229, v[220:221]
  ds_write_b32 v232, v222
  s_waitcnt lgkmcnt(0)
  s_barrier
  ds_read_b128 v[152:155], v6
  ds_read_b128 v[156:159], v6 offset:256
  ds_read_b64_tr_b16 v[128:129], v5 offset:0
  ds_read_b64_tr_b16 v[130:131], v5 offset:4608
  ds_read_b64_tr_b16 v[132:133], v5 offset:9216
  ds_read_b64_tr_b16 v[134:135], v5 offset:13824
  s_waitcnt lgkmcnt(5)
  v_max_f32 v160, v152, v153
  v_max3_f32 v160, v160, v154, v155
  v_mov_b32 v161, v160
  s_nop 1
  v_permlane16_swap_b32 v160, v161
  v_max_f32 v160, v160, v161
  v_mov_b32 v161, v160
  s_nop 1
  v_permlane32_swap_b32 v160, v161
  v_max_f32 v160, v160, v161
  v_sub_f32 v152, v152, v160
  v_sub_f32 v153, v153, v160
  v_sub_f32 v154, v154, v160
  v_sub_f32 v155, v155, v160
  v_exp_f32 v152, v152
  v_exp_f32 v153, v153
  v_exp_f32 v154, v154
  v_exp_f32 v155, v155
  s_waitcnt lgkmcnt(4)
  v_mul_f32 v162, v152, v156
  v_fmac_f32 v162, v153, v157
  v_fmac_f32 v162, v154, v158
  v_fmac_f32 v162, v155, v159
  v_mov_b32 v161, v162
  s_nop 1
  v_permlane16_swap_b32 v162, v161
  v_add_f32 v162, v162, v161
  v_mov_b32 v161, v162
  s_nop 1
  v_permlane32_swap_b32 v162, v161
  v_add_f32 v162, v162, v161
  v_rcp_f32 v162, v162
  s_nop 0
  v_mul_f32 v152, v152, v162
  v_mul_f32 v153, v153, v162
  v_mul_f32 v154, v154, v162
  v_mul_f32 v155, v155, v162
  v_cvt_pk_bf16_f32 v152, v152, v153
  v_cvt_pk_bf16_f32 v153, v154, v155
  v_cndmask_b32 v136, 0, v152, s[12:13]
  v_cndmask_b32 v137, 0, v153, s[12:13]
  v_cndmask_b32 v138, 0, v152, s[14:15]
  v_cndmask_b32 v139, 0, v153, s[14:15]
  v_cndmask_b32 v140, 0, v152, s[16:17]
  v_cndmask_b32 v141, 0, v153, s[16:17]
  v_cndmask_b32 v142, 0, v152, s[18:19]
  v_cndmask_b32 v143, 0, v153, s[18:19]
  s_waitcnt lgkmcnt(0)
  v_mfma_f32_16x16x32_bf16 v[144:147], v[128:131], v[136:139], 0
  v_mfma_f32_16x16x32_bf16 v[144:147], v[132:135], v[140:143], v[144:147]
  s_nop 7
  v_cvt_pk_bf16_f32 v148, v144, v145
  v_cvt_pk_bf16_f32 v149, v146, v147
  s_mov_b64 exec, s[58:59]
  ds_write_b64 v7, v[148:149] offset:20480
  s_mov_b64 exec, -1
  s_waitcnt lgkmcnt(0)
  s_barrier
  ds_read_b128 v[164:167], v8 offset:20480
  ds_read_b128 v[168:171], v8 offset:20544
  ds_read_b128 v[172:175], v8 offset:20608
  ds_read_b128 v[176:179], v8 offset:20672
  s_waitcnt lgkmcnt(3)
  v_mfma_f32_16x16x32_bf16 v[144:147], v[32:35], v[164:167], 0
  s_waitcnt lgkmcnt(2)
  v_mfma_f32_16x16x32_bf16 v[144:147], v[36:39], v[168:171], v[144:147]
  s_waitcnt lgkmcnt(1)
  v_mfma_f32_16x16x32_bf16 v[144:147], v[40:43], v[172:175], v[144:147]
  s_waitcnt lgkmcnt(0)
  v_mfma_f32_16x16x32_bf16 v[144:147], v[44:47], v[176:179], v[144:147]
  s_nop 7
  v_cvt_pk_bf16_f32 v148, v144, v145
  v_cvt_pk_bf16_f32 v149, v146, v147
  s_mov_b64 exec, s[58:59]
  ds_write_b64 v7, v[148:149] offset:21632
  s_mov_b64 exec, -1
  s_waitcnt lgkmcnt(0)
  s_barrier
  ds_read_b128 v[164:167], v8 offset:21632
  ds_read_b128 v[168:171], v8 offset:21696
  ds_read_b128 v[172:175], v8 offset:21760
  ds_read_b128 v[176:179], v8 offset:21824
  s_waitcnt lgkmcnt(0)
  v_mfma_f32_16x16x32_bf16 v[192:195], v[48:51], v[164:167], 0
  v_mfma_f32_16x16x32_bf16 v[192:195], v[52:55], v[168:171], v[192:195]
  v_mfma_f32_16x16x32_bf16 v[192:195], v[56:59], v[172:175], v[192:195]
  v_mfma_f32_16x16x32_bf16 v[192:195], v[60:63], v[176:179], v[192:195]
  v_mfma_f32_16x16x32_bf16 v[196:199], v[64:67], v[164:167], 0
  v_mfma_f32_16x16x32_bf16 v[196:199], v[68:71], v[168:171], v[196:199]
  v_mfma_f32_16x16x32_bf16 v[196:199], v[72:75], v[172:175], v[196:199]
  v_mfma_f32_16x16x32_bf16 v[196:199], v[76:79], v[176:179], v[196:199]
  v_mfma_f32_16x16x32_bf16 v[200:203], v[80:83], v[164:167], 0
  v_mfma_f32_16x16x32_bf16 v[200:203], v[84:87], v[168:171], v[200:203]
  v_mfma_f32_16x16x32_bf16 v[200:203], v[88:91], v[172:175], v[200:203]
  v_mfma_f32_16x16x32_bf16 v[200:203], v[92:95], v[176:179], v[200:203]
  v_mfma_f32_16x16x32_bf16 v[204:207], v[96:99], v[164:167], 0
  v_mfma_f32_16x16x32_bf16 v[204:207], v[100:103], v[168:171], v[204:207]
  v_mfma_f32_16x16x32_bf16 v[204:207], v[104:107], v[172:175], v[204:207]
  v_mfma_f32_16x16x32_bf16 v[204:207], v[108:111], v[176:179], v[204:207]
  v_mov_b32 v215, s35
  v_mov_b32 v219, s35
  s_cmp_ge_u32 s36, 4
  s_cbranch_scc1 L_m5_21
  v_mfma_f32_16x16x32_bf16 v[208:211], v[112:115], v[164:167], 0
  v_mfma_f32_16x16x32_bf16 v[208:211], v[116:119], v[168:171], v[208:211]
  v_mfma_f32_16x16x32_bf16 v[208:211], v[120:123], v[172:175], v[208:211]
  v_mfma_f32_16x16x32_bf16 v[208:211], v[124:127], v[176:179], v[208:211]
L_m5_21:
  s_nop 3
  v_cndmask_b32 v192, v192, v196, s[84:85]
  v_cndmask_b32 v193, v193, v197, s[84:85]
  v_cndmask_b32 v194, v194, v198, s[84:85]
  v_cndmask_b32 v195, v195, v199, s[84:85]
  v_cndmask_b32 v192, v192, v200, s[86:87]
  v_cndmask_b32 v193, v193, v201, s[86:87]
  v_cndmask_b32 v194, v194, v202, s[86:87]
  v_cndmask_b32 v195, v195, v203, s[86:87]
  s_nop 3
  v_cndmask_b32 v192, v192, v204, s[88:89]
  v_cndmask_b32 v193, v193, v205, s[88:89]
  v_cndmask_b32 v194, v194, v206, s[88:89]
  v_cndmask_b32 v195, v195, v207, s[88:89]
  v_fma_f32 v192, v192, v12, v180
  v_fma_f32 v193, v193, v12, v181
  v_fma_f32 v194, v194, v12, v182
  v_fma_f32 v195, v195, v12, v183
  v_add_u32 v192, 0x80, v192
  v_add_u32 v193, 0x80, v193
  v_add_u32 v194, 0x80, v194
  v_add_u32 v195, 0x80, v195
  v_perm_b32 v212, v192, v195, s50
  v_perm_b32 v213, v193, v195, s51
  v_perm_b32 v214, v194, v195, s57
  global_store_dwordx4 v11, v[212:215], s[32:33] offset:0 sc1
  s_cmp_ge_u32 s36, 4
  s_cbranch_scc1 L_m6_22
  v_fma_f32 v208, v208, v12, v184
  v_fma_f32 v209, v209, v12, v185
  v_fma_f32 v210, v210, v12, v186
  v_fma_f32 v211, v211, v12, v187
  v_add_u32 v208, 0x80, v208
  v_add_u32 v209, 0x80, v209
  v_add_u32 v210, 0x80, v210
  v_add_u32 v211, 0x80, v211
  v_perm_b32 v216, v208, v211, s50
  v_perm_b32 v217, v209, v211, s51
  v_perm_b32 v218, v210, v211, s57
  s_mov_b64 exec, s[58:59]
  global_store_dwordx4 v11, v[216:219], s[32:33] offset:1024 sc1
  s_mov_b64 exec, -1
L_m6_22:
  s_endpgm
L_A:
  s_mov_b32 s41, s43
  s_and_b32 s40, s41, 1
  s_lshr_b32 s39, s41, 5
  s_mov_b32 s44, s6
  s_and_b32 s45, s7, 0xffff
  s_mov_b32 s46, 16777216
  s_mov_b32 s47, 0x00020000
  v_lshrrev_b32 v16, 3, v1
  v_and_b32 v17, 6, v16
  v_and_b32 v4, 7, v1
  v_xor_b32 v17, v17, v4
  v_lshlrev_b32 v17, 4, v17
  v_mul_u32_u24 v16, 1024, v16
  v_add_u32 v4, v16, v17
  s_lshr_b32 s48, s41, 1
  s_lshl_b32 s48, s48, 18
  s_lshl_b32 s51, s36, 13
  s_add_u32 s50, s48, s51
  s_lshl_b32 s48, s40, 17
  s_add_u32 s52, s50, s48
  s_xor_b32 s48, s48, 0x20000
  s_add_u32 s53, s50, s48
  s_lshr_b32 s60, s41, 4
  s_and_b32 s61, s41, 15
  v_mov_b32 v16, 157776
  v_mov_b32 v17, 0
  v_lshl_add_u32 v16, v1, 2, v16
  s_mov_b64 exec, 0xf
  ds_write_b32 v16, v17
  s_mov_b64 exec, -1
  s_waitcnt lgkmcnt(0)
  s_barrier
  s_load_dword s34, s[32:33], 0
  s_cmp_ge_u32 s36, 4
  s_cbranch_scc1 L_nodma_23
  s_and_b32 s48, s43, 15
  s_lshl_b32 s48, s48, 5
  s_lshl_b32 s49, s36, 2
  s_add_u32 s48, s48, s49
  s_lshl_b32 s48, s48, 13
  s_lshr_b32 s49, s43, 4
  s_lshl_b32 s49, s49, 10
  s_add_u32 s48, s48, s49
  v_lshl_add_u32 v16, v1, 4, s48
  global_load_dwordx4 v[60:63], v16, s[10:11]
  v_add_u32 v16, 8192, v16
  global_load_dwordx4 v[64:67], v16, s[10:11]
  v_add_u32 v16, 8192, v16
  global_load_dwordx4 v[68:71], v16, s[10:11]
  v_add_u32 v16, 8192, v16
  global_load_dwordx4 v[72:75], v16, s[10:11]
  s_add_u32 s48, s52, 0
  s_add_u32 m0, s51, 0
  s_nop 0
  buffer_load_dwordx4 v4, s[44:47], s48 offen lds
  s_add_u32 s48, s52, 128
  s_add_u32 m0, s51, 1024
  s_nop 0
  buffer_load_dwordx4 v4, s[44:47], s48 offen lds
  s_add_u32 s48, s52, 256
  s_add_u32 m0, s51, 2048
  s_nop 0
  buffer_load_dwordx4 v4, s[44:47], s48 offen lds
  s_add_u32 s48, s52, 384
  s_add_u32 m0, s51, 3072
  s_nop 0
  buffer_load_dwordx4 v4, s[44:47], s48 offen lds
  s_add_u32 s48, s52, 512
  s_add_u32 m0, s51, 4096
  s_nop 0
  buffer_load_dwordx4 v4, s[44:47], s48 offen lds
  s_add_u32 s48, s52, 640
  s_add_u32 m0, s51, 5120
  s_nop 0
  buffer_load_dwordx4 v4, s[44:47], s48 offen lds
  s_add_u32 s48, s52, 768
  s_add_u32 m0, s51, 6144
  s_nop 0
  buffer_load_dwordx4 v4, s[44:47], s48 offen lds
  s_add_u32 s48, s52, 896
  s_add_u32 m0, s51, 7168
  s_nop 0
  buffer_load_dwordx4 v4, s[44:47], s48 offen lds
  s_branch L_sm_25
L_nodma_23:
  s_setprio 3
  s_and_b32 s56, s36, 3
  s_min_u32 s56, s56, 2
  s_mul_i32 s48, s61, 576
  s_mul_i32 s49, s56, 192
  s_add_u32 s48, s48, s49
  v_lshl_add_u32 v16, v1, 1, s48
  global_load_ushort v188, v16, s[18:19]
  global_load_ushort v189, v16, s[20:21]
  global_load_ushort v190, v16, s[22:23]
  v_and_b32 v16, 31, v1
  s_add_u32 s48, s48, 128
  v_lshl_add_u32 v17, v16, 1, s48
  global_load_ushort v191, v17, s[18:19]
  global_load_ushort v192, v17, s[20:21]
  global_load_ushort v193, v17, s[22:23]
  s_lshr_b32 s48, s60, 1
  s_mul_i32 s48, s48, 1152
  s_and_b32 s49, s60, 1
  s_mul_i32 s49, s49, 576
  s_add_u32 s49, s49, s48
  s_add_u32 s56, s56, 6
  s_lshl_b32 s56, s56, 6
  s_add_u32 s49, s49, s56
  v_lshl_add_u32 v17, v16, 1, s49
  global_load_ushort v252, v17, s[4:5]
  s_cmp_lg_u32 s36, 7
  s_cbranch_scc1 L_sm_24
  v_lshlrev_b32 v16, 2, v1
  v_add_u32 v17, s48, v16
  global_load_dword v194, v17, s[4:5] offset:0
  global_load_dword v199, v16, s[26:27] offset:0
  global_load_dword v195, v17, s[4:5] offset:256
  global_load_dword v200, v16, s[26:27] offset:256
  global_load_dword v196, v17, s[4:5] offset:512
  global_load_dword v201, v16, s[26:27] offset:512
  global_load_dword v197, v17, s[4:5] offset:768
  global_load_dword v202, v16, s[26:27] offset:768
  v_add_u32 v16, 1024, v16
  v_min_u32 v16, 1148, v16
  v_add_u32 v17, s48, v16
  global_load_dword v198, v17, s[4:5]
  global_load_dword v203, v16, s[26:27]
L_sm_24:
  s_and_b32 s48, s43, 15
  s_lshl_b32 s48, s48, 5
  s_lshl_b32 s49, s36, 2
  s_add_u32 s48, s48, s49
  s_lshl_b32 s48, s48, 13
  s_lshr_b32 s49, s43, 4
  s_lshl_b32 s49, s49, 10
  s_add_u32 s48, s48, s49
  v_lshl_add_u32 v16, v1, 4, s48
  global_load_dwordx4 v[60:63], v16, s[10:11]
  v_add_u32 v16, 8192, v16
  global_load_dwordx4 v[64:67], v16, s[10:11]
  v_add_u32 v16, 8192, v16
  global_load_dwordx4 v[68:71], v16, s[10:11]
  v_add_u32 v16, 8192, v16
  global_load_dwordx4 v[72:75], v16, s[10:11]
L_sm_25:
  v_and_b32 v16, 1, v3
  v_lshlrev_b32 v16, 2, v16
  v_lshrrev_b32 v17, 2, v2
  v_add_u32 v16, v16, v17
  v_bfe_u32 v17, v2, 1, 1
  v_and_b32 v20, 6, v16
  v_xor_b32 v17, v17, v20
  v_lshlrev_b32 v17, 4, v17
  v_lshl_add_u32 v17, v16, 7, v17
  v_and_b32 v16, 1, v2
  v_lshl_add_u32 v17, v16, 3, v17
  v_lshrrev_b32 v16, 1, v3
  v_mul_u32_u24 v16, 8192, v16
  v_add_u32 v20, v16, v17
  s_lshl_b32 s48, s36, 10
  v_add_u32 v20, s48, v20
  v_xor_b32 v21, 32, v20
  v_xor_b32 v22, 64, v20
  v_xor_b32 v23, 96, v20
  v_add_u32 v24, 0x10000, v20
  v_add_u32 v25, 0x10000, v21
  v_add_u32 v26, 0x10000, v22
  v_add_u32 v27, 0x10000, v23
  v_and_b32 v16, 7, v2
  v_and_b32 v17, 6, v16
  v_xor_b32 v17, v17, v3
  v_lshlrev_b32 v17, 4, v17
  v_lshl_add_u32 v17, v16, 7, v17
  v_lshrrev_b32 v16, 3, v2
  s_lshl_b32 s48, s36, 1
  v_add_u32 v16, s48, v16
  v_lshl_add_u32 v5, v16, 13, v17
  v_xor_b32 v6, 64, v5
  v_mul_u32_u24 v7, 1056, v2
  v_lshl_add_u32 v7, v3, 4, v7
  v_add_u32 v7, 131072, v7
  v_mul_u32_u24 v8, 544, v2
  v_lshl_add_u32 v8, v3, 4, v8
  v_add_u32 v8, 147968, v8
  s_lshr_b32 s48, s36, 1
  s_lshl_b32 s48, s48, 6
  s_and_b32 s49, s36, 1
  s_lshl_b32 s49, s49, 3
  s_add_u32 s48, s48, s49
  v_add_u32 v9, s48, v8
  v_lshlrev_b32 v11, 5, v2
  v_add_u32 v11, 156672, v11
  s_lshl_b32 s48, s36, 2
  v_add_u32 v10, s48, v11
  v_and_b32 v16, 1, v3
  v_cmp_eq_u32 s[62:63], 1, v16
  s_lshl_b32 s48, s39, 5
  s_lshl_b32 s49, s40, 4
  s_add_u32 s48, s48, s49
  s_lshl_b32 s48, s48, 11
  s_add_u32 s57, s48, 528384
  v_and_b32 v16, 511, v0
  v_lshl_add_u32 v12, v16, 4, s57
  v_lshrrev_b32 v17, 7, v16
  v_mul_u32_u24 v17, 1056, v17
  v_and_b32 v16, 127, v16
  v_lshl_add_u32 v13, v16, 3, v17
  v_add_u32 v13, 131072, v13
  v_lshlrev_b32 v14, 9, v1
  v_add_u32 v14, 508, v14
  v_add_u32 v14, s57, v14
  s_add_u32 s92, s32, 4096
  s_addc_u32 s93, s33, 0
  s_add_u32 s94, s32, 12288
  s_addc_u32 s95, s33, 0
  s_add_u32 s96, s32, 20480
  s_addc_u32 s97, s33, 0
  s_add_u32 s98, s32, 28672
  s_addc_u32 s99, s33, 0
  s_cmp_lt_u32 s36, 4
  s_cbranch_scc1 L_ms_26
  s_waitcnt vmcnt(4)
  s_cmp_eq_u32 s36, 7
  s_cbranch_scc1 L_ms_27
  v_lshlrev_b32 v188, 16, v188
  v_lshlrev_b32 v189, 16, v189
  v_lshlrev_b32 v190, 16, v190
  s_mov_b32 s48, 0xc0135761
  s_mov_b32 s49, 0xbdd2d3e8
  v_mul_f32 v214, v189, v189
  v_mul_f32 v209, v188, v188
  v_mul_f32 v208, v209, v188
  v_mul_f32 v208, s49, v208
  v_mul_f32 v209, v209, v189
  v_mov_b32 v210, s48
  v_mov_b32 v211, s48
  v_fmac_f32 v211, s49, v214
  s_mov_b32 s49, 0xbe9e1eee
  v_mul_f32 v209, s49, v209
  v_fmac_f32 v210, s49, v214
  v_mul_f32 v210, v210, v188
  v_mul_f32 v211, v211, v189
  v_mul_f32 v212, v188, v190
  v_mul_f32 v213, v189, v190
  v_cvt_pk_bf16_f32 v216, v208, v208
  v_and_b32 v216, 0xffff0000, v216
  v_sub_f32 v217, v208, v216
  v_cvt_pk_bf16_f32 v218, v209, v209
  v_and_b32 v218, 0xffff0000, v218
  v_sub_f32 v219, v209, v218
  v_cvt_pk_bf16_f32 v236, v216, v217
  v_cvt_pk_bf16_f32 v237, v216, v218
  v_cvt_pk_bf16_f32 v238, v219, v218
  v_cvt_pk_bf16_f32 v216, v210, v210
  v_and_b32 v216, 0xffff0000, v216
  v_sub_f32 v217, v210, v216
  v_cvt_pk_bf16_f32 v239, v216, v217
  v_cvt_pk_bf16_f32 v216, v211, v211
  v_and_b32 v216, 0xffff0000, v216
  v_sub_f32 v217, v211, v216
  v_cvt_pk_bf16_f32 v240, v216, v217
  v_cvt_pk_bf16_f32 v216, v212, v212
  v_and_b32 v216, 0xffff0000, v216
  v_sub_f32 v217, v212, v216
  v_cvt_pk_bf16_f32 v241, v216, v217
  v_cvt_pk_bf16_f32 v216, v213, v213
  v_and_b32 v216, 0xffff0000, v216
  v_sub_f32 v217, v213, v216
  v_cvt_pk_bf16_f32 v242, v216, v217
  v_mov_b32 v243, 0
  s_sub_u32 s56, s36, 4
  s_mul_i32 s56, s56, 3072
  s_add_u32 s56, s56, 147968
  v_lshl_add_u32 v16, v1, 5, s56
  ds_write_b128 v16, v[236:239]
  ds_write_b128 v16, v[240:243] offset:16
  v_lshlrev_b32 v191, 16, v191
  v_lshlrev_b32 v192, 16, v192
  v_lshlrev_b32 v193, 16, v193
  s_mov_b32 s48, 0xc0135761
  s_mov_b32 s49, 0xbdd2d3e8
  v_mul_f32 v214, v192, v192
  v_mul_f32 v209, v191, v191
  v_mul_f32 v208, v209, v191
  v_mul_f32 v208, s49, v208
  v_mul_f32 v209, v209, v192
  v_mov_b32 v210, s48
  v_mov_b32 v211, s48
  v_fmac_f32 v211, s49, v214
  s_mov_b32 s49, 0xbe9e1eee
  v_mul_f32 v209, s49, v209
  v_fmac_f32 v210, s49, v214
  v_mul_f32 v210, v210, v191
  v_mul_f32 v211, v211, v192
  v_mul_f32 v212, v191, v193
  v_mul_f32 v213, v192, v193
  v_cvt_pk_bf16_f32 v216, v208, v208
  v_and_b32 v216, 0xffff0000, v216
  v_sub_f32 v217, v208, v216
  v_cvt_pk_bf16_f32 v218, v209, v209
  v_and_b32 v218, 0xffff0000, v218
  v_sub_f32 v219, v209, v218
  v_cvt_pk_bf16_f32 v244, v216, v217
  v_cvt_pk_bf16_f32 v245, v216, v218
  v_cvt_pk_bf16_f32 v246, v219, v218
  v_cvt_pk_bf16_f32 v216, v210, v210
  v_and_b32 v216, 0xffff0000, v216
  v_sub_f32 v217, v210, v216
  v_cvt_pk_bf16_f32 v247, v216, v217
  v_cvt_pk_bf16_f32 v216, v211, v211
  v_and_b32 v216, 0xffff0000, v216
  v_sub_f32 v217, v211, v216
  v_cvt_pk_bf16_f32 v248, v216, v217
  v_cvt_pk_bf16_f32 v216, v212, v212
  v_and_b32 v216, 0xffff0000, v216
  v_sub_f32 v217, v212, v216
  v_cvt_pk_bf16_f32 v249, v216, v217
  v_cvt_pk_bf16_f32 v216, v213, v213
  v_and_b32 v216, 0xffff0000, v216
  v_sub_f32 v217, v213, v216
  v_cvt_pk_bf16_f32 v250, v216, v217
  v_mov_b32 v251, 0
  s_mov_b32 exec_hi, 0
  ds_write_b128 v16, v[244:247] offset:2048
  ds_write_b128 v16, v[248:251] offset:2064
  s_mov_b64 exec, -1
  s_branch L_ms_28
L_ms_27:
  v_lshlrev_b32 v208, 16, v194
  v_and_b32 v209, 0xffff0000, v194
  v_lshlrev_b32 v218, 16, v199
  v_and_b32 v219, 0xffff0000, v199
  v_lshlrev_b32 v210, 16, v195
  v_and_b32 v211, 0xffff0000, v195
  v_lshlrev_b32 v220, 16, v200
  v_and_b32 v221, 0xffff0000, v200
  v_lshlrev_b32 v212, 16, v196
  v_and_b32 v213, 0xffff0000, v196
  v_lshlrev_b32 v222, 16, v201
  v_and_b32 v223, 0xffff0000, v201
  v_lshlrev_b32 v214, 16, v197
  v_and_b32 v215, 0xffff0000, v197
  v_lshlrev_b32 v224, 16, v202
  v_and_b32 v225, 0xffff0000, v202
  v_lshlrev_b32 v216, 16, v198
  v_and_b32 v217, 0xffff0000, v198
  v_lshlrev_b32 v226, 16, v203
  v_and_b32 v227, 0xffff0000, v203
  v_cmp_gt_u32 vcc, 32, v1
  s_nop 1
  v_cndmask_b32 v216, 0, v216, vcc
  v_cndmask_b32 v217, 0, v217, vcc
  v_cndmask_b32 v226, 0, v226, vcc
  v_cndmask_b32 v227, 0, v227, vcc
  v_add_f32 v232, v208, v209
  v_mul_f32 v233, v208, v218
  v_add_f32 v232, v232, v210
  v_add_f32 v232, v232, v211
  v_add_f32 v232, v232, v212
  v_add_f32 v232, v232, v213
  v_add_f32 v232, v232, v214
  v_add_f32 v232, v232, v215
  v_add_f32 v232, v232, v216
  v_add_f32 v232, v232, v217
  v_fmac_f32 v233, v209, v219
  v_fmac_f32 v233, v210, v220
  v_fmac_f32 v233, v211, v221
  v_fmac_f32 v233, v212, v222
  v_fmac_f32 v233, v213, v223
  v_fmac_f32 v233, v214, v224
  v_fmac_f32 v233, v215, v225
  v_fmac_f32 v233, v216, v226
  v_fmac_f32 v233, v217, v227
  v_add_f32_dpp v232, v232, v232 row_ror:8 row_mask:0xf bank_mask:0xf
  s_nop 0
  v_add_f32_dpp v233, v233, v233 row_ror:8 row_mask:0xf bank_mask:0xf
  v_add_f32_dpp v232, v232, v232 row_ror:4 row_mask:0xf bank_mask:0xf
  s_nop 0
  v_add_f32_dpp v233, v233, v233 row_ror:4 row_mask:0xf bank_mask:0xf
  v_add_f32_dpp v232, v232, v232 row_ror:2 row_mask:0xf bank_mask:0xf
  s_nop 0
  v_add_f32_dpp v233, v233, v233 row_ror:2 row_mask:0xf bank_mask:0xf
  v_add_f32_dpp v232, v232, v232 row_ror:1 row_mask:0xf bank_mask:0xf
  s_nop 0
  v_add_f32_dpp v233, v233, v233 row_ror:1 row_mask:0xf bank_mask:0xf
  v_mov_b32 v235, v232
  v_mov_b32 v236, v233
  s_nop 0
  v_permlane16_swap_b32 v232, v235
  v_permlane16_swap_b32 v233, v236
  v_add_f32 v232, v232, v235
  v_add_f32 v233, v233, v236
  v_mov_b32 v235, v232
  v_mov_b32 v236, v233
  s_nop 0
  v_permlane32_swap_b32 v232, v235
  v_permlane32_swap_b32 v233, v236
  v_add_f32 v232, v232, v235
  v_add_f32 v233, v233, v236
  s_mov_b32 s48, 0x3ae38e39
  v_mul_f32 v232, s48, v232
  v_sub_f32 v208, v208, v232
  v_sub_f32 v209, v209, v232
  v_sub_f32 v210, v210, v232
  v_sub_f32 v211, v211, v232
  v_sub_f32 v212, v212, v232
  v_sub_f32 v213, v213, v232
  v_sub_f32 v214, v214, v232
  v_sub_f32 v215, v215, v232
  v_sub_f32 v216, v216, v232
  v_sub_f32 v217, v217, v232
  v_cndmask_b32 v216, 0, v216, vcc
  v_cndmask_b32 v217, 0, v217, vcc
  v_mul_f32 v234, v208, v208
  v_fmac_f32 v234, v209, v209
  v_fmac_f32 v234, v210, v210
  v_fmac_f32 v234, v211, v211
  v_fmac_f32 v234, v212, v212
  v_fmac_f32 v234, v213, v213
  v_fmac_f32 v234, v214, v214
  v_fmac_f32 v234, v215, v215
  v_fmac_f32 v234, v216, v216
  v_fmac_f32 v234, v217, v217
  s_nop 1
  v_add_f32_dpp v234, v234, v234 row_ror:8 row_mask:0xf bank_mask:0xf
  s_nop 1
  v_add_f32_dpp v234, v234, v234 row_ror:4 row_mask:0xf bank_mask:0xf
  s_nop 1
  v_add_f32_dpp v234, v234, v234 row_ror:2 row_mask:0xf bank_mask:0xf
  s_nop 1
  v_add_f32_dpp v234, v234, v234 row_ror:1 row_mask:0xf bank_mask:0xf
  v_mov_b32 v235, v234
  s_nop 1
  v_permlane16_swap_b32 v234, v235
  v_add_f32 v234, v234, v235
  v_mov_b32 v235, v234
  s_nop 1
  v_permlane32_swap_b32 v234, v235
  v_add_f32 v234, v234, v235
  v_mov_b32 v235, 0x3727c5ac
  v_fmac_f32 v235, s48, v234
  v_rsq_f32 v210, v235
  s_mov_b32 s49, 0xbfb8aa3b
  v_mul_f32 v233, s49, v233
  v_exp_f32 v233, v233
  s_nop 0
  v_add_f32 v233, 1.0, v233
  v_rcp_f32 v208, v233
  v_mov_b32 v209, v232
  v_mov_b32 v211, 0
  v_mov_b32 v235, 157760
  s_mov_b64 exec, 1
  ds_write_b128 v235, v[208:211]
  s_mov_b64 exec, -1
L_ms_28:
  s_waitcnt lgkmcnt(0)
  s_mul_i32 s35, s34, 0x9e3779b1
  s_add_u32 s35, s35, 0x7f4a7c15
  s_lshl_b32 s48, s36, 2
  s_add_u32 s48, s48, 157760
  v_mov_b32 v235, s48
  v_mov_b32 v236, s35
  s_waitcnt lgkmcnt(0)
  ds_write_b32 v235, v236
  s_cmp_lg_u32 s36, 7
  s_cbranch_scc1 L_sp_29_n
  s_waitcnt vmcnt(0)
  s_branch L_ms_26
L_sp_29_n:
  v_mov_b32 v235, 157776
  s_mov_b32 s56, 0
L_sp_29:
  ds_read_b128 v[208:211], v235
  s_waitcnt lgkmcnt(0)
  v_cmp_eq_u32 vcc, s35, v208
  v_cmp_eq_u32 s[54:55], s35, v209
  s_and_b64 vcc, vcc, s[54:55]
  v_cmp_eq_u32 s[54:55], s35, v210
  s_and_b64 vcc, vcc, s[54:55]
  v_cmp_eq_u32 s[54:55], s35, v211
  s_and_b64 vcc, vcc, s[54:55]
  s_cmp_eq_u64 vcc, -1
  s_cbranch_scc1 L_sp_29_d
  s_add_u32 s56, s56, 1
  s_cmp_lt_u32 s56, 800000
  s_cbranch_scc1 L_sp_29
L_sp_29_d:
  v_mov_b32 v240, 157760
  ds_read_b128 v[242:245], v240
  v_and_b32 v254, 31, v1
  v_lshlrev_b32 v254, 5, v254
  v_lshrrev_b32 v240, 5, v1
  v_lshl_add_u32 v254, v240, 4, v254
  v_add_u32 v254, 147968, v254
  ds_read_b128 v[220:223], v254
  s_waitcnt lgkmcnt(1)
  v_mov_b32 v253, v242
  v_mov_b32 v188, v243
  v_mov_b32 v189, v244
  v_lshlrev_b32 v191, 16, v252
  v_sub_f32 v191, v191, v188
  v_mul_f32 v191, v191, v189
  v_cvt_pk_bf16_f32 v191, v191, v191
  v_and_b32 v192, 0xffff0000, v191
  v_mul_f32 v193, v192, v192
  v_mul_f32 v194, v193, v192
  v_cvt_pk_bf16_f32 v195, v193, v193
  v_and_b32 v195, 0xffff0000, v195
  v_sub_f32 v196, v193, v195
  v_cvt_pk_bf16_f32 v197, v194, v194
  v_and_b32 v197, 0xffff0000, v197
  v_sub_f32 v198, v194, v197
  v_cvt_pk_bf16_f32 v228, v197, v197
  v_cvt_pk_bf16_f32 v229, v198, v195
  v_cvt_pk_bf16_f32 v230, v195, v196
  v_mov_b32 v231, v191
  v_cmp_gt_u32 vcc, 32, v1
  v_mov_b32 v199, 0x3f803f80
  s_nop 0
  v_cndmask_b32 v228, v199, v228, vcc
  v_cndmask_b32 v229, 0, v229, vcc
  v_cndmask_b32 v230, 0, v230, vcc
  v_cndmask_b32 v231, 0, v231, vcc
  v_mov_b32 v232, 0
  v_cndmask_b32 v233, v191, 0, vcc
  v_cndmask_b32 v234, v199, 0, vcc
  v_mov_b32 v235, 0
  v_mov_b32 v236, 0
  v_mov_b32 v237, 0
  v_mov_b32 v238, 0
  v_mov_b32 v239, 0
  s_waitcnt lgkmcnt(0)
  v_mfma_f32_32x32x16_bf16 v[188:203], v[220:223], v[228:231], 0
  v_mfma_f32_32x32x16_bf16 v[204:219], v[220:223], v[232:235], 0
  ds_read_b128 v[224:227], v254 offset:1024
  s_nop 9
  v_exp_f32 v188, v188
  v_exp_f32 v189, v189
  v_exp_f32 v190, v190
  v_exp_f32 v191, v191
  v_exp_f32 v192, v192
  v_exp_f32 v193, v193
  v_exp_f32 v194, v194
  v_exp_f32 v195, v195
  v_exp_f32 v196, v196
  v_exp_f32 v197, v197
  v_exp_f32 v198, v198
  v_exp_f32 v199, v199
  v_exp_f32 v200, v200
  v_exp_f32 v201, v201
  v_exp_f32 v202, v202
  v_exp_f32 v203, v203
  v_pk_add_f32 v[188:189], v[188:189], 1.0 op_sel_hi:[1,0]
  v_pk_add_f32 v[190:191], v[190:191], 1.0 op_sel_hi:[1,0]
  v_pk_add_f32 v[192:193], v[192:193], 1.0 op_sel_hi:[1,0]
  v_pk_add_f32 v[194:195], v[194:195], 1.0 op_sel_hi:[1,0]
  v_pk_add_f32 v[196:197], v[196:197], 1.0 op_sel_hi:[1,0]
  v_pk_add_f32 v[198:199], v[198:199], 1.0 op_sel_hi:[1,0]
  v_pk_add_f32 v[200:201], v[200:201], 1.0 op_sel_hi:[1,0]
  v_pk_add_f32 v[202:203], v[202:203], 1.0 op_sel_hi:[1,0]
  v_rcp_f32 v188, v188
  v_rcp_f32 v189, v189
  v_rcp_f32 v190, v190
  v_rcp_f32 v191, v191
  v_rcp_f32 v192, v192
  v_rcp_f32 v193, v193
  v_rcp_f32 v194, v194
  v_rcp_f32 v195, v195
  v_rcp_f32 v196, v196
  v_rcp_f32 v197, v197
  v_rcp_f32 v198, v198
  v_rcp_f32 v199, v199
  v_rcp_f32 v200, v200
  v_rcp_f32 v201, v201
  v_rcp_f32 v202, v202
  v_rcp_f32 v203, v203
  v_pk_fma_f32 v[236:237], v[204:205], v[188:189], v[236:237]
  v_pk_fma_f32 v[238:239], v[206:207], v[190:191], v[238:239]
  v_pk_fma_f32 v[236:237], v[208:209], v[192:193], v[236:237]
  v_pk_fma_f32 v[238:239], v[210:211], v[194:195], v[238:239]
  v_pk_fma_f32 v[236:237], v[212:213], v[196:197], v[236:237]
  v_pk_fma_f32 v[238:239], v[214:215], v[198:199], v[238:239]
  v_pk_fma_f32 v[236:237], v[216:217], v[200:201], v[236:237]
  v_pk_fma_f32 v[238:239], v[218:219], v[202:203], v[238:239]
  s_waitcnt lgkmcnt(0)
  v_mfma_f32_32x32x16_bf16 v[188:203], v[224:227], v[228:231], 0
  v_mfma_f32_32x32x16_bf16 v[204:219], v[224:227], v[232:235], 0
  ds_read_b128 v[220:223], v254 offset:2048
  s_nop 9
  v_exp_f32 v188, v188
  v_exp_f32 v189, v189
  v_exp_f32 v190, v190
  v_exp_f32 v191, v191
  v_exp_f32 v192, v192
  v_exp_f32 v193, v193
  v_exp_f32 v194, v194
  v_exp_f32 v195, v195
  v_exp_f32 v196, v196
  v_exp_f32 v197, v197
  v_exp_f32 v198, v198
  v_exp_f32 v199, v199
  v_exp_f32 v200, v200
  v_exp_f32 v201, v201
  v_exp_f32 v202, v202
  v_exp_f32 v203, v203
  v_pk_add_f32 v[188:189], v[188:189], 1.0 op_sel_hi:[1,0]
  v_pk_add_f32 v[190:191], v[190:191], 1.0 op_sel_hi:[1,0]
  v_pk_add_f32 v[192:193], v[192:193], 1.0 op_sel_hi:[1,0]
  v_pk_add_f32 v[194:195], v[194:195], 1.0 op_sel_hi:[1,0]
  v_pk_add_f32 v[196:197], v[196:197], 1.0 op_sel_hi:[1,0]
  v_pk_add_f32 v[198:199], v[198:199], 1.0 op_sel_hi:[1,0]
  v_pk_add_f32 v[200:201], v[200:201], 1.0 op_sel_hi:[1,0]
  v_pk_add_f32 v[202:203], v[202:203], 1.0 op_sel_hi:[1,0]
  v_rcp_f32 v188, v188
  v_rcp_f32 v189, v189
  v_rcp_f32 v190, v190
  v_rcp_f32 v191, v191
  v_rcp_f32 v192, v192
  v_rcp_f32 v193, v193
  v_rcp_f32 v194, v194
  v_rcp_f32 v195, v195
  v_rcp_f32 v196, v196
  v_rcp_f32 v197, v197
  v_rcp_f32 v198, v198
  v_rcp_f32 v199, v199
  v_rcp_f32 v200, v200
  v_rcp_f32 v201, v201
  v_rcp_f32 v202, v202
  v_rcp_f32 v203, v203
  v_pk_fma_f32 v[236:237], v[204:205], v[188:189], v[236:237]
  v_pk_fma_f32 v[238:239], v[206:207], v[190:191], v[238:239]
  v_pk_fma_f32 v[236:237], v[208:209], v[192:193], v[236:237]
  v_pk_fma_f32 v[238:239], v[210:211], v[194:195], v[238:239]
  v_pk_fma_f32 v[236:237], v[212:213], v[196:197], v[236:237]
  v_pk_fma_f32 v[238:239], v[214:215], v[198:199], v[238:239]
  v_pk_fma_f32 v[236:237], v[216:217], v[200:201], v[236:237]
  v_pk_fma_f32 v[238:239], v[218:219], v[202:203], v[238:239]
  s_waitcnt lgkmcnt(0)
  v_mfma_f32_32x32x16_bf16 v[188:203], v[220:223], v[228:231], 0
  v_mfma_f32_32x32x16_bf16 v[204:219], v[220:223], v[232:235], 0
  ds_read_b128 v[224:227], v254 offset:3072
  s_nop 9
  v_exp_f32 v188, v188
  v_exp_f32 v189, v189
  v_exp_f32 v190, v190
  v_exp_f32 v191, v191
  v_exp_f32 v192, v192
  v_exp_f32 v193, v193
  v_exp_f32 v194, v194
  v_exp_f32 v195, v195
  v_exp_f32 v196, v196
  v_exp_f32 v197, v197
  v_exp_f32 v198, v198
  v_exp_f32 v199, v199
  v_exp_f32 v200, v200
  v_exp_f32 v201, v201
  v_exp_f32 v202, v202
  v_exp_f32 v203, v203
  v_pk_add_f32 v[188:189], v[188:189], 1.0 op_sel_hi:[1,0]
  v_pk_add_f32 v[190:191], v[190:191], 1.0 op_sel_hi:[1,0]
  v_pk_add_f32 v[192:193], v[192:193], 1.0 op_sel_hi:[1,0]
  v_pk_add_f32 v[194:195], v[194:195], 1.0 op_sel_hi:[1,0]
  v_pk_add_f32 v[196:197], v[196:197], 1.0 op_sel_hi:[1,0]
  v_pk_add_f32 v[198:199], v[198:199], 1.0 op_sel_hi:[1,0]
  v_pk_add_f32 v[200:201], v[200:201], 1.0 op_sel_hi:[1,0]
  v_pk_add_f32 v[202:203], v[202:203], 1.0 op_sel_hi:[1,0]
  v_rcp_f32 v188, v188
  v_rcp_f32 v189, v189
  v_rcp_f32 v190, v190
  v_rcp_f32 v191, v191
  v_rcp_f32 v192, v192
  v_rcp_f32 v193, v193
  v_rcp_f32 v194, v194
  v_rcp_f32 v195, v195
  v_rcp_f32 v196, v196
  v_rcp_f32 v197, v197
  v_rcp_f32 v198, v198
  v_rcp_f32 v199, v199
  v_rcp_f32 v200, v200
  v_rcp_f32 v201, v201
  v_rcp_f32 v202, v202
  v_rcp_f32 v203, v203
  v_pk_fma_f32 v[236:237], v[204:205], v[188:189], v[236:237]
  v_pk_fma_f32 v[238:239], v[206:207], v[190:191], v[238:239]
  v_pk_fma_f32 v[236:237], v[208:209], v[192:193], v[236:237]
  v_pk_fma_f32 v[238:239], v[210:211], v[194:195], v[238:239]
  v_pk_fma_f32 v[236:237], v[212:213], v[196:197], v[236:237]
  v_pk_fma_f32 v[238:239], v[214:215], v[198:199], v[238:239]
  v_pk_fma_f32 v[236:237], v[216:217], v[200:201], v[236:237]
  v_pk_fma_f32 v[238:239], v[218:219], v[202:203], v[238:239]
  s_waitcnt lgkmcnt(0)
  v_mfma_f32_32x32x16_bf16 v[188:203], v[224:227], v[228:231], 0
  v_mfma_f32_32x32x16_bf16 v[204:219], v[224:227], v[232:235], 0
  ds_read_b128 v[220:223], v254 offset:4096
  s_nop 9
  v_exp_f32 v188, v188
  v_exp_f32 v189, v189
  v_exp_f32 v190, v190
  v_exp_f32 v191, v191
  v_exp_f32 v192, v192
  v_exp_f32 v193, v193
  v_exp_f32 v194, v194
  v_exp_f32 v195, v195
  v_exp_f32 v196, v196
  v_exp_f32 v197, v197
  v_exp_f32 v198, v198
  v_exp_f32 v199, v199
  v_exp_f32 v200, v200
  v_exp_f32 v201, v201
  v_exp_f32 v202, v202
  v_exp_f32 v203, v203
  v_pk_add_f32 v[188:189], v[188:189], 1.0 op_sel_hi:[1,0]
  v_pk_add_f32 v[190:191], v[190:191], 1.0 op_sel_hi:[1,0]
  v_pk_add_f32 v[192:193], v[192:193], 1.0 op_sel_hi:[1,0]
  v_pk_add_f32 v[194:195], v[194:195], 1.0 op_sel_hi:[1,0]
  v_pk_add_f32 v[196:197], v[196:197], 1.0 op_sel_hi:[1,0]
  v_pk_add_f32 v[198:199], v[198:199], 1.0 op_sel_hi:[1,0]
  v_pk_add_f32 v[200:201], v[200:201], 1.0 op_sel_hi:[1,0]
  v_pk_add_f32 v[202:203], v[202:203], 1.0 op_sel_hi:[1,0]
  v_rcp_f32 v188, v188
  v_rcp_f32 v189, v189
  v_rcp_f32 v190, v190
  v_rcp_f32 v191, v191
  v_rcp_f32 v192, v192
  v_rcp_f32 v193, v193
  v_rcp_f32 v194, v194
  v_rcp_f32 v195, v195
  v_rcp_f32 v196, v196
  v_rcp_f32 v197, v197
  v_rcp_f32 v198, v198
  v_rcp_f32 v199, v199
  v_rcp_f32 v200, v200
  v_rcp_f32 v201, v201
  v_rcp_f32 v202, v202
  v_rcp_f32 v203, v203
  v_pk_fma_f32 v[236:237], v[204:205], v[188:189], v[236:237]
  v_pk_fma_f32 v[238:239], v[206:207], v[190:191], v[238:239]
  v_pk_fma_f32 v[236:237], v[208:209], v[192:193], v[236:237]
  v_pk_fma_f32 v[238:239], v[210:211], v[194:195], v[238:239]
  v_pk_fma_f32 v[236:237], v[212:213], v[196:197], v[236:237]
  v_pk_fma_f32 v[238:239], v[214:215], v[198:199], v[238:239]
  v_pk_fma_f32 v[236:237], v[216:217], v[200:201], v[236:237]
  v_pk_fma_f32 v[238:239], v[218:219], v[202:203], v[238:239]
L_ms_26:
  s_cmp_ge_u32 s36, 4
  s_cbranch_scc1 L_up_30
  s_add_u32 s48, s52, 32768
  s_add_u32 m0, s51, 32768
  s_nop 0
  buffer_load_dwordx4 v4, s[44:47], s48 offen lds
  s_add_u32 s48, s52, 32896
  s_add_u32 m0, s51, 33792
  s_nop 0
  buffer_load_dwordx4 v4, s[44:47], s48 offen lds
  s_add_u32 s48, s52, 33024
  s_add_u32 m0, s51, 34816
  s_nop 0
  buffer_load_dwordx4 v4, s[44:47], s48 offen lds
  s_add_u32 s48, s52, 33152
  s_add_u32 m0, s51, 35840
  s_nop 0
  buffer_load_dwordx4 v4, s[44:47], s48 offen lds
  s_add_u32 s48, s52, 33280
  s_add_u32 m0, s51, 36864
  s_nop 0
  buffer_load_dwordx4 v4, s[44:47], s48 offen lds
  s_add_u32 s48, s52, 33408
  s_add_u32 m0, s51, 37888
  s_nop 0
  buffer_load_dwordx4 v4, s[44:47], s48 offen lds
  s_add_u32 s48, s52, 33536
  s_add_u32 m0, s51, 38912
  s_nop 0
  buffer_load_dwordx4 v4, s[44:47], s48 offen lds
  s_add_u32 s48, s52, 33664
  s_add_u32 m0, s51, 39936
  s_nop 0
  buffer_load_dwordx4 v4, s[44:47], s48 offen lds
  s_add_u32 s48, s52, 65536
  s_add_u32 m0, s51, 65536
  s_nop 0
  buffer_load_dwordx4 v4, s[44:47], s48 offen lds
  s_add_u32 s48, s52, 65664
  s_add_u32 m0, s51, 66560
  s_nop 0
  buffer_load_dwordx4 v4, s[44:47], s48 offen lds
  s_add_u32 s48, s52, 65792
  s_add_u32 m0, s51, 67584
  s_nop 0
  buffer_load_dwordx4 v4, s[44:47], s48 offen lds
  s_add_u32 s48, s52, 65920
  s_add_u32 m0, s51, 68608
  s_nop 0
  buffer_load_dwordx4 v4, s[44:47], s48 offen lds
  s_add_u32 s48, s52, 66048
  s_add_u32 m0, s51, 69632
  s_nop 0
  buffer_load_dwordx4 v4, s[44:47], s48 offen lds
  s_add_u32 s48, s52, 66176
  s_add_u32 m0, s51, 70656
  s_nop 0
  buffer_load_dwordx4 v4, s[44:47], s48 offen lds
  s_add_u32 s48, s52, 66304
  s_add_u32 m0, s51, 71680
  s_nop 0
  buffer_load_dwordx4 v4, s[44:47], s48 offen lds
  s_add_u32 s48, s52, 66432
  s_add_u32 m0, s51, 72704
  s_nop 0
  buffer_load_dwordx4 v4, s[44:47], s48 offen lds
  s_add_u32 s48, s52, 98304
  s_add_u32 m0, s51, 98304
  s_nop 0
  buffer_load_dwordx4 v4, s[44:47], s48 offen lds
  s_add_u32 s48, s52, 98432
  s_add_u32 m0, s51, 99328
  s_nop 0
  buffer_load_dwordx4 v4, s[44:47], s48 offen lds
  s_add_u32 s48, s52, 98560
  s_add_u32 m0, s51, 100352
  s_nop 0
  buffer_load_dwordx4 v4, s[44:47], s48 offen lds
  s_add_u32 s48, s52, 98688
  s_add_u32 m0, s51, 101376
  s_nop 0
  buffer_load_dwordx4 v4, s[44:47], s48 offen lds
  s_add_u32 s48, s52, 98816
  s_add_u32 m0, s51, 102400
  s_nop 0
  buffer_load_dwordx4 v4, s[44:47], s48 offen lds
  s_add_u32 s48, s52, 98944
  s_add_u32 m0, s51, 103424
  s_nop 0
  buffer_load_dwordx4 v4, s[44:47], s48 offen lds
  s_add_u32 s48, s52, 99072
  s_add_u32 m0, s51, 104448
  s_nop 0
  buffer_load_dwordx4 v4, s[44:47], s48 offen lds
  s_add_u32 s48, s52, 99200
  s_add_u32 m0, s51, 105472
  s_nop 0
  buffer_load_dwordx4 v4, s[44:47], s48 offen lds
L_up_30:
  s_cmp_ge_u32 s36, 4
  s_cbranch_scc1 L_cp_31
  s_waitcnt vmcnt(16)
L_cp_31:
  s_barrier
  ds_read_b64_tr_b16 v[124:125], v20 offset:0
  ds_read_b64_tr_b16 v[126:127], v20 offset:16384
  ds_read_b64_tr_b16 v[140:141], v21 offset:0
  ds_read_b64_tr_b16 v[142:143], v21 offset:16384
  ds_read_b64_tr_b16 v[156:157], v22 offset:0
  ds_read_b64_tr_b16 v[158:159], v22 offset:16384
  ds_read_b64_tr_b16 v[172:173], v23 offset:0
  ds_read_b64_tr_b16 v[174:175], v23 offset:16384
  ds_read_b64_tr_b16 v[128:129], v20 offset:32768
  ds_read_b64_tr_b16 v[130:131], v20 offset:49152
  ds_read_b64_tr_b16 v[144:145], v21 offset:32768
  ds_read_b64_tr_b16 v[146:147], v21 offset:49152
  ds_read_b64_tr_b16 v[160:161], v22 offset:32768
  ds_read_b64_tr_b16 v[162:163], v22 offset:49152
  ds_read_b64_tr_b16 v[176:177], v23 offset:32768
  ds_read_b64_tr_b16 v[178:179], v23 offset:49152
  s_lshr_b32 s48, s36, 1
  s_cmp_lg_u32 s48, 0
  s_cbranch_scc1 L_cp_33
  ds_read_b128 v[60:63], v5 offset:0
  ds_read_b128 v[64:67], v6 offset:0
  ds_read_b128 v[68:71], v5 offset:1024
  ds_read_b128 v[72:75], v6 offset:1024
  ds_read_b128 v[76:79], v5 offset:2048
  ds_read_b128 v[80:83], v6 offset:2048
  ds_read_b128 v[84:87], v5 offset:3072
  ds_read_b128 v[88:91], v6 offset:3072
  ds_read_b128 v[92:95], v5 offset:4096
  ds_read_b128 v[96:99], v6 offset:4096
  ds_read_b128 v[100:103], v5 offset:5120
  ds_read_b128 v[104:107], v6 offset:5120
  ds_read_b128 v[108:111], v5 offset:6144
  ds_read_b128 v[112:115], v6 offset:6144
  ds_read_b128 v[116:119], v5 offset:7168
  ds_read_b128 v[120:123], v6 offset:7168
L_cp_33:
  s_lshr_b32 s48, s36, 1
  s_cmp_lg_u32 s48, 1
  s_cbranch_scc1 L_cp_34
  ds_read_b128 v[60:63], v5 offset:0
  ds_read_b128 v[64:67], v6 offset:0
  ds_read_b128 v[68:71], v5 offset:1024
  ds_read_b128 v[72:75], v6 offset:1024
  ds_read_b128 v[76:79], v5 offset:2048
  ds_read_b128 v[80:83], v6 offset:2048
  ds_read_b128 v[84:87], v5 offset:3072
  ds_read_b128 v[88:91], v6 offset:3072
  ds_read_b128 v[92:95], v5 offset:4096
  ds_read_b128 v[96:99], v6 offset:4096
  ds_read_b128 v[100:103], v5 offset:5120
  ds_read_b128 v[104:107], v6 offset:5120
  ds_read_b128 v[108:111], v5 offset:6144
  ds_read_b128 v[112:115], v6 offset:6144
  ds_read_b128 v[116:119], v5 offset:7168
  ds_read_b128 v[120:123], v6 offset:7168
L_cp_34:
  s_waitcnt lgkmcnt(0)
  s_barrier
  s_cmp_ge_u32 s36, 4
  s_cbranch_scc1 L_cp_32
  s_add_u32 s48, s53, 0
  s_add_u32 m0, s51, 0
  s_nop 0
  buffer_load_dwordx4 v4, s[44:47], s48 offen lds
  s_add_u32 s48, s53, 128
  s_add_u32 m0, s51, 1024
  s_nop 0
  buffer_load_dwordx4 v4, s[44:47], s48 offen lds
  s_add_u32 s48, s53, 256
  s_add_u32 m0, s51, 2048
  s_nop 0
  buffer_load_dwordx4 v4, s[44:47], s48 offen lds
  s_add_u32 s48, s53, 384
  s_add_u32 m0, s51, 3072
  s_nop 0
  buffer_load_dwordx4 v4, s[44:47], s48 offen lds
  s_add_u32 s48, s53, 512
  s_add_u32 m0, s51, 4096
  s_nop 0
  buffer_load_dwordx4 v4, s[44:47], s48 offen lds
  s_add_u32 s48, s53, 640
  s_add_u32 m0, s51, 5120
  s_nop 0
  buffer_load_dwordx4 v4, s[44:47], s48 offen lds
  s_add_u32 s48, s53, 768
  s_add_u32 m0, s51, 6144
  s_nop 0
  buffer_load_dwordx4 v4, s[44:47], s48 offen lds
  s_add_u32 s48, s53, 896
  s_add_u32 m0, s51, 7168
  s_nop 0
  buffer_load_dwordx4 v4, s[44:47], s48 offen lds
  s_add_u32 s48, s53, 32768
  s_add_u32 m0, s51, 32768
  s_nop 0
  buffer_load_dwordx4 v4, s[44:47], s48 offen lds
  s_add_u32 s48, s53, 32896
  s_add_u32 m0, s51, 33792
  s_nop 0
  buffer_load_dwordx4 v4, s[44:47], s48 offen lds
  s_add_u32 s48, s53, 33024
  s_add_u32 m0, s51, 34816
  s_nop 0
  buffer_load_dwordx4 v4, s[44:47], s48 offen lds
  s_add_u32 s48, s53, 33152
  s_add_u32 m0, s51, 35840
  s_nop 0
  buffer_load_dwordx4 v4, s[44:47], s48 offen lds
  s_add_u32 s48, s53, 33280
  s_add_u32 m0, s51, 36864
  s_nop 0
  buffer_load_dwordx4 v4, s[44:47], s48 offen lds
  s_add_u32 s48, s53, 33408
  s_add_u32 m0, s51, 37888
  s_nop 0
  buffer_load_dwordx4 v4, s[44:47], s48 offen lds
  s_add_u32 s48, s53, 33536
  s_add_u32 m0, s51, 38912
  s_nop 0
  buffer_load_dwordx4 v4, s[44:47], s48 offen lds
  s_add_u32 s48, s53, 33664
  s_add_u32 m0, s51, 39936
  s_nop 0
  buffer_load_dwordx4 v4, s[44:47], s48 offen lds
L_cp_32:
  s_cmp_lt_u32 s36, 4
  s_cbranch_scc1 L_mr_35
  s_cmp_eq_u32 s36, 7
  s_cbranch_scc1 L_mr_35
  s_waitcnt lgkmcnt(0)
  v_mfma_f32_32x32x16_bf16 v[188:203], v[220:223], v[228:231], 0
  v_mfma_f32_32x32x16_bf16 v[204:219], v[220:223], v[232:235], 0
  ds_read_b128 v[224:227], v254 offset:5120
  s_nop 9
  v_exp_f32 v188, v188
  v_exp_f32 v189, v189
  v_exp_f32 v190, v190
  v_exp_f32 v191, v191
  v_exp_f32 v192, v192
  v_exp_f32 v193, v193
  v_exp_f32 v194, v194
  v_exp_f32 v195, v195
  v_exp_f32 v196, v196
  v_exp_f32 v197, v197
  v_exp_f32 v198, v198
  v_exp_f32 v199, v199
  v_exp_f32 v200, v200
  v_exp_f32 v201, v201
  v_exp_f32 v202, v202
  v_exp_f32 v203, v203
  v_pk_add_f32 v[188:189], v[188:189], 1.0 op_sel_hi:[1,0]
  v_pk_add_f32 v[190:191], v[190:191], 1.0 op_sel_hi:[1,0]
  v_pk_add_f32 v[192:193], v[192:193], 1.0 op_sel_hi:[1,0]
  v_pk_add_f32 v[194:195], v[194:195], 1.0 op_sel_hi:[1,0]
  v_pk_add_f32 v[196:197], v[196:197], 1.0 op_sel_hi:[1,0]
  v_pk_add_f32 v[198:199], v[198:199], 1.0 op_sel_hi:[1,0]
  v_pk_add_f32 v[200:201], v[200:201], 1.0 op_sel_hi:[1,0]
  v_pk_add_f32 v[202:203], v[202:203], 1.0 op_sel_hi:[1,0]
  v_rcp_f32 v188, v188
  v_rcp_f32 v189, v189
  v_rcp_f32 v190, v190
  v_rcp_f32 v191, v191
  v_rcp_f32 v192, v192
  v_rcp_f32 v193, v193
  v_rcp_f32 v194, v194
  v_rcp_f32 v195, v195
  v_rcp_f32 v196, v196
  v_rcp_f32 v197, v197
  v_rcp_f32 v198, v198
  v_rcp_f32 v199, v199
  v_rcp_f32 v200, v200
  v_rcp_f32 v201, v201
  v_rcp_f32 v202, v202
  v_rcp_f32 v203, v203
  v_pk_fma_f32 v[236:237], v[204:205], v[188:189], v[236:237]
  v_pk_fma_f32 v[238:239], v[206:207], v[190:191], v[238:239]
  v_pk_fma_f32 v[236:237], v[208:209], v[192:193], v[236:237]
  v_pk_fma_f32 v[238:239], v[210:211], v[194:195], v[238:239]
  v_pk_fma_f32 v[236:237], v[212:213], v[196:197], v[236:237]
  v_pk_fma_f32 v[238:239], v[214:215], v[198:199], v[238:239]
  v_pk_fma_f32 v[236:237], v[216:217], v[200:201], v[236:237]
  v_pk_fma_f32 v[238:239], v[218:219], v[202:203], v[238:239]
  s_waitcnt lgkmcnt(0)
  v_mfma_f32_32x32x16_bf16 v[188:203], v[224:227], v[228:231], 0
  v_mfma_f32_32x32x16_bf16 v[204:219], v[224:227], v[232:235], 0
  ds_read_b128 v[220:223], v254 offset:6144
  s_nop 9
  v_exp_f32 v188, v188
  v_exp_f32 v189, v189
  v_exp_f32 v190, v190
  v_exp_f32 v191, v191
  v_exp_f32 v192, v192
  v_exp_f32 v193, v193
  v_exp_f32 v194, v194
  v_exp_f32 v195, v195
  v_exp_f32 v196, v196
  v_exp_f32 v197, v197
  v_exp_f32 v198, v198
  v_exp_f32 v199, v199
  v_exp_f32 v200, v200
  v_exp_f32 v201, v201
  v_exp_f32 v202, v202
  v_exp_f32 v203, v203
  v_pk_add_f32 v[188:189], v[188:189], 1.0 op_sel_hi:[1,0]
  v_pk_add_f32 v[190:191], v[190:191], 1.0 op_sel_hi:[1,0]
  v_pk_add_f32 v[192:193], v[192:193], 1.0 op_sel_hi:[1,0]
  v_pk_add_f32 v[194:195], v[194:195], 1.0 op_sel_hi:[1,0]
  v_pk_add_f32 v[196:197], v[196:197], 1.0 op_sel_hi:[1,0]
  v_pk_add_f32 v[198:199], v[198:199], 1.0 op_sel_hi:[1,0]
  v_pk_add_f32 v[200:201], v[200:201], 1.0 op_sel_hi:[1,0]
  v_pk_add_f32 v[202:203], v[202:203], 1.0 op_sel_hi:[1,0]
  v_rcp_f32 v188, v188
  v_rcp_f32 v189, v189
  v_rcp_f32 v190, v190
  v_rcp_f32 v191, v191
  v_rcp_f32 v192, v192
  v_rcp_f32 v193, v193
  v_rcp_f32 v194, v194
  v_rcp_f32 v195, v195
  v_rcp_f32 v196, v196
  v_rcp_f32 v197, v197
  v_rcp_f32 v198, v198
  v_rcp_f32 v199, v199
  v_rcp_f32 v200, v200
  v_rcp_f32 v201, v201
  v_rcp_f32 v202, v202
  v_rcp_f32 v203, v203
  v_pk_fma_f32 v[236:237], v[204:205], v[188:189], v[236:237]
  v_pk_fma_f32 v[238:239], v[206:207], v[190:191], v[238:239]
  v_pk_fma_f32 v[236:237], v[208:209], v[192:193], v[236:237]
  v_pk_fma_f32 v[238:239], v[210:211], v[194:195], v[238:239]
  v_pk_fma_f32 v[236:237], v[212:213], v[196:197], v[236:237]
  v_pk_fma_f32 v[238:239], v[214:215], v[198:199], v[238:239]
  v_pk_fma_f32 v[236:237], v[216:217], v[200:201], v[236:237]
  v_pk_fma_f32 v[238:239], v[218:219], v[202:203], v[238:239]
  s_waitcnt lgkmcnt(0)
  v_mfma_f32_32x32x16_bf16 v[188:203], v[220:223], v[228:231], 0
  v_mfma_f32_32x32x16_bf16 v[204:219], v[220:223], v[232:235], 0
  ds_read_b128 v[224:227], v254 offset:7168
  s_nop 9
  v_exp_f32 v188, v188
  v_exp_f32 v189, v189
  v_exp_f32 v190, v190
  v_exp_f32 v191, v191
  v_exp_f32 v192, v192
  v_exp_f32 v193, v193
  v_exp_f32 v194, v194
  v_exp_f32 v195, v195
  v_exp_f32 v196, v196
  v_exp_f32 v197, v197
  v_exp_f32 v198, v198
  v_exp_f32 v199, v199
  v_exp_f32 v200, v200
  v_exp_f32 v201, v201
  v_exp_f32 v202, v202
  v_exp_f32 v203, v203
  v_pk_add_f32 v[188:189], v[188:189], 1.0 op_sel_hi:[1,0]
  v_pk_add_f32 v[190:191], v[190:191], 1.0 op_sel_hi:[1,0]
  v_pk_add_f32 v[192:193], v[192:193], 1.0 op_sel_hi:[1,0]
  v_pk_add_f32 v[194:195], v[194:195], 1.0 op_sel_hi:[1,0]
  v_pk_add_f32 v[196:197], v[196:197], 1.0 op_sel_hi:[1,0]
  v_pk_add_f32 v[198:199], v[198:199], 1.0 op_sel_hi:[1,0]
  v_pk_add_f32 v[200:201], v[200:201], 1.0 op_sel_hi:[1,0]
  v_pk_add_f32 v[202:203], v[202:203], 1.0 op_sel_hi:[1,0]
  v_rcp_f32 v188, v188
  v_rcp_f32 v189, v189
  v_rcp_f32 v190, v190
  v_rcp_f32 v191, v191
  v_rcp_f32 v192, v192
  v_rcp_f32 v193, v193
  v_rcp_f32 v194, v194
  v_rcp_f32 v195, v195
  v_rcp_f32 v196, v196
  v_rcp_f32 v197, v197
  v_rcp_f32 v198, v198
  v_rcp_f32 v199, v199
  v_rcp_f32 v200, v200
  v_rcp_f32 v201, v201
  v_rcp_f32 v202, v202
  v_rcp_f32 v203, v203
  v_pk_fma_f32 v[236:237], v[204:205], v[188:189], v[236:237]
  v_pk_fma_f32 v[238:239], v[206:207], v[190:191], v[238:239]
  v_pk_fma_f32 v[236:237], v[208:209], v[192:193], v[236:237]
  v_pk_fma_f32 v[238:239], v[210:211], v[194:195], v[238:239]
  v_pk_fma_f32 v[236:237], v[212:213], v[196:197], v[236:237]
  v_pk_fma_f32 v[238:239], v[214:215], v[198:199], v[238:239]
  v_pk_fma_f32 v[236:237], v[216:217], v[200:201], v[236:237]
  v_pk_fma_f32 v[238:239], v[218:219], v[202:203], v[238:239]
  s_waitcnt lgkmcnt(0)
  v_mfma_f32_32x32x16_bf16 v[188:203], v[224:227], v[228:231], 0
  v_mfma_f32_32x32x16_bf16 v[204:219], v[224:227], v[232:235], 0
  ds_read_b128 v[220:223], v254 offset:8192
  s_nop 9
  v_exp_f32 v188, v188
  v_exp_f32 v189, v189
  v_exp_f32 v190, v190
  v_exp_f32 v191, v191
  v_exp_f32 v192, v192
  v_exp_f32 v193, v193
  v_exp_f32 v194, v194
  v_exp_f32 v195, v195
  v_exp_f32 v196, v196
  v_exp_f32 v197, v197
  v_exp_f32 v198, v198
  v_exp_f32 v199, v199
  v_exp_f32 v200, v200
  v_exp_f32 v201, v201
  v_exp_f32 v202, v202
  v_exp_f32 v203, v203
  v_pk_add_f32 v[188:189], v[188:189], 1.0 op_sel_hi:[1,0]
  v_pk_add_f32 v[190:191], v[190:191], 1.0 op_sel_hi:[1,0]
  v_pk_add_f32 v[192:193], v[192:193], 1.0 op_sel_hi:[1,0]
  v_pk_add_f32 v[194:195], v[194:195], 1.0 op_sel_hi:[1,0]
  v_pk_add_f32 v[196:197], v[196:197], 1.0 op_sel_hi:[1,0]
  v_pk_add_f32 v[198:199], v[198:199], 1.0 op_sel_hi:[1,0]
  v_pk_add_f32 v[200:201], v[200:201], 1.0 op_sel_hi:[1,0]
  v_pk_add_f32 v[202:203], v[202:203], 1.0 op_sel_hi:[1,0]
  v_rcp_f32 v188, v188
  v_rcp_f32 v189, v189
  v_rcp_f32 v190, v190
  v_rcp_f32 v191, v191
  v_rcp_f32 v192, v192
  v_rcp_f32 v193, v193
  v_rcp_f32 v194, v194
  v_rcp_f32 v195, v195
  v_rcp_f32 v196, v196
  v_rcp_f32 v197, v197
  v_rcp_f32 v198, v198
  v_rcp_f32 v199, v199
  v_rcp_f32 v200, v200
  v_rcp_f32 v201, v201
  v_rcp_f32 v202, v202
  v_rcp_f32 v203, v203
  v_pk_fma_f32 v[236:237], v[204:205], v[188:189], v[236:237]
  v_pk_fma_f32 v[238:239], v[206:207], v[190:191], v[238:239]
  v_pk_fma_f32 v[236:237], v[208:209], v[192:193], v[236:237]
  v_pk_fma_f32 v[238:239], v[210:211], v[194:195], v[238:239]
  v_pk_fma_f32 v[236:237], v[212:213], v[196:197], v[236:237]
  v_pk_fma_f32 v[238:239], v[214:215], v[198:199], v[238:239]
  v_pk_fma_f32 v[236:237], v[216:217], v[200:201], v[236:237]
  v_pk_fma_f32 v[238:239], v[218:219], v[202:203], v[238:239]
  s_waitcnt lgkmcnt(0)
  v_mfma_f32_32x32x16_bf16 v[188:203], v[220:223], v[228:231], 0
  v_mfma_f32_32x32x16_bf16 v[204:219], v[220:223], v[232:235], 0
  s_nop 10
  v_exp_f32 v188, v188
  v_exp_f32 v189, v189
  v_exp_f32 v190, v190
  v_exp_f32 v191, v191
  v_exp_f32 v192, v192
  v_exp_f32 v193, v193
  v_exp_f32 v194, v194
  v_exp_f32 v195, v195
  v_exp_f32 v196, v196
  v_exp_f32 v197, v197
  v_exp_f32 v198, v198
  v_exp_f32 v199, v199
  v_exp_f32 v200, v200
  v_exp_f32 v201, v201
  v_exp_f32 v202, v202
  v_exp_f32 v203, v203
  v_pk_add_f32 v[188:189], v[188:189], 1.0 op_sel_hi:[1,0]
  v_pk_add_f32 v[190:191], v[190:191], 1.0 op_sel_hi:[1,0]
  v_pk_add_f32 v[192:193], v[192:193], 1.0 op_sel_hi:[1,0]
  v_pk_add_f32 v[194:195], v[194:195], 1.0 op_sel_hi:[1,0]
  v_pk_add_f32 v[196:197], v[196:197], 1.0 op_sel_hi:[1,0]
  v_pk_add_f32 v[198:199], v[198:199], 1.0 op_sel_hi:[1,0]
  v_pk_add_f32 v[200:201], v[200:201], 1.0 op_sel_hi:[1,0]
  v_pk_add_f32 v[202:203], v[202:203], 1.0 op_sel_hi:[1,0]
  v_rcp_f32 v188, v188
  v_rcp_f32 v189, v189
  v_rcp_f32 v190, v190
  v_rcp_f32 v191, v191
  v_rcp_f32 v192, v192
  v_rcp_f32 v193, v193
  v_rcp_f32 v194, v194
  v_rcp_f32 v195, v195
  v_rcp_f32 v196, v196
  v_rcp_f32 v197, v197
  v_rcp_f32 v198, v198
  v_rcp_f32 v199, v199
  v_rcp_f32 v200, v200
  v_rcp_f32 v201, v201
  v_rcp_f32 v202, v202
  v_rcp_f32 v203, v203
  v_pk_fma_f32 v[236:237], v[204:205], v[188:189], v[236:237]
  v_pk_fma_f32 v[238:239], v[206:207], v[190:191], v[238:239]
  v_pk_fma_f32 v[236:237], v[208:209], v[192:193], v[236:237]
  v_pk_fma_f32 v[238:239], v[210:211], v[194:195], v[238:239]
  v_pk_fma_f32 v[236:237], v[212:213], v[196:197], v[236:237]
  v_pk_fma_f32 v[238:239], v[214:215], v[198:199], v[238:239]
  v_pk_fma_f32 v[236:237], v[216:217], v[200:201], v[236:237]
  v_pk_fma_f32 v[238:239], v[218:219], v[202:203], v[238:239]
  v_add_f32 v236, v236, v237
  v_add_f32 v238, v238, v239
  v_add_f32 v236, v236, v238
  v_mov_b32 v237, v236
  s_nop 1
  v_permlane32_swap_b32 v236, v237
  v_add_f32 v236, v236, v237
  v_sub_f32 v237, 1.0, v253
  v_mul_f32 v236, v236, v237
  v_mov_b32 v237, 0
  v_mov_b32 v238, 0
  v_mov_b32 v239, s35
  s_mul_i32 s48, s41, 1536
  s_sub_u32 s49, s36, 4
  s_lshl_b32 s49, s49, 9
  s_add_u32 s48, s48, s49
  s_add_u32 s48, s48, 5115904
  v_lshl_add_u32 v240, v1, 4, s48
  s_mov_b32 exec_hi, 0
  global_store_dwordx4 v240, v[236:239], s[32:33] sc1
  s_mov_b64 exec, -1
L_mr_35:
  s_setprio 0
  s_cmp_ge_u32 s36, 4
  s_cbranch_scc1 L_cp_36
  s_waitcnt vmcnt(16)
L_cp_36:
  s_barrier
  ds_read_b64_tr_b16 v[132:133], v24 offset:0
  ds_read_b64_tr_b16 v[134:135], v24 offset:16384
  ds_read_b64_tr_b16 v[148:149], v25 offset:0
  ds_read_b64_tr_b16 v[150:151], v25 offset:16384
  ds_read_b64_tr_b16 v[164:165], v26 offset:0
  ds_read_b64_tr_b16 v[166:167], v26 offset:16384
  ds_read_b64_tr_b16 v[180:181], v27 offset:0
  ds_read_b64_tr_b16 v[182:183], v27 offset:16384
  ds_read_b64_tr_b16 v[136:137], v24 offset:32768
  ds_read_b64_tr_b16 v[138:139], v24 offset:49152
  ds_read_b64_tr_b16 v[152:153], v25 offset:32768
  ds_read_b64_tr_b16 v[154:155], v25 offset:49152
  ds_read_b64_tr_b16 v[168:169], v26 offset:32768
  ds_read_b64_tr_b16 v[170:171], v26 offset:49152
  ds_read_b64_tr_b16 v[184:185], v27 offset:32768
  ds_read_b64_tr_b16 v[186:187], v27 offset:49152
  s_lshr_b32 s48, s36, 1
  s_cmp_lg_u32 s48, 2
  s_cbranch_scc1 L_cp_38
  ds_read_b128 v[60:63], v5 offset:0
  ds_read_b128 v[64:67], v6 offset:0
  ds_read_b128 v[68:71], v5 offset:1024
  ds_read_b128 v[72:75], v6 offset:1024
  ds_read_b128 v[76:79], v5 offset:2048
  ds_read_b128 v[80:83], v6 offset:2048
  ds_read_b128 v[84:87], v5 offset:3072
  ds_read_b128 v[88:91], v6 offset:3072
  ds_read_b128 v[92:95], v5 offset:4096
  ds_read_b128 v[96:99], v6 offset:4096
  ds_read_b128 v[100:103], v5 offset:5120
  ds_read_b128 v[104:107], v6 offset:5120
  ds_read_b128 v[108:111], v5 offset:6144
  ds_read_b128 v[112:115], v6 offset:6144
  ds_read_b128 v[116:119], v5 offset:7168
  ds_read_b128 v[120:123], v6 offset:7168
L_cp_38:
  s_lshr_b32 s48, s36, 1
  s_cmp_lg_u32 s48, 3
  s_cbranch_scc1 L_cp_39
  ds_read_b128 v[60:63], v5 offset:0
  ds_read_b128 v[64:67], v6 offset:0
  ds_read_b128 v[68:71], v5 offset:1024
  ds_read_b128 v[72:75], v6 offset:1024
  ds_read_b128 v[76:79], v5 offset:2048
  ds_read_b128 v[80:83], v6 offset:2048
  ds_read_b128 v[84:87], v5 offset:3072
  ds_read_b128 v[88:91], v6 offset:3072
  ds_read_b128 v[92:95], v5 offset:4096
  ds_read_b128 v[96:99], v6 offset:4096
  ds_read_b128 v[100:103], v5 offset:5120
  ds_read_b128 v[104:107], v6 offset:5120
  ds_read_b128 v[108:111], v5 offset:6144
  ds_read_b128 v[112:115], v6 offset:6144
  ds_read_b128 v[116:119], v5 offset:7168
  ds_read_b128 v[120:123], v6 offset:7168
L_cp_39:
  s_waitcnt lgkmcnt(0)
  s_barrier
  s_cmp_ge_u32 s36, 4
  s_cbranch_scc1 L_cp_37
  s_add_u32 s48, s53, 65536
  s_add_u32 m0, s51, 65536
  s_nop 0
  buffer_load_dwordx4 v4, s[44:47], s48 offen lds
  s_add_u32 s48, s53, 65664
  s_add_u32 m0, s51, 66560
  s_nop 0
  buffer_load_dwordx4 v4, s[44:47], s48 offen lds
  s_add_u32 s48, s53, 65792
  s_add_u32 m0, s51, 67584
  s_nop 0
  buffer_load_dwordx4 v4, s[44:47], s48 offen lds
  s_add_u32 s48, s53, 65920
  s_add_u32 m0, s51, 68608
  s_nop 0
  buffer_load_dwordx4 v4, s[44:47], s48 offen lds
  s_add_u32 s48, s53, 66048
  s_add_u32 m0, s51, 69632
  s_nop 0
  buffer_load_dwordx4 v4, s[44:47], s48 offen lds
  s_add_u32 s48, s53, 66176
  s_add_u32 m0, s51, 70656
  s_nop 0
  buffer_load_dwordx4 v4, s[44:47], s48 offen lds
  s_add_u32 s48, s53, 66304
  s_add_u32 m0, s51, 71680
  s_nop 0
  buffer_load_dwordx4 v4, s[44:47], s48 offen lds
  s_add_u32 s48, s53, 66432
  s_add_u32 m0, s51, 72704
  s_nop 0
  buffer_load_dwordx4 v4, s[44:47], s48 offen lds
  s_add_u32 s48, s53, 98304
  s_add_u32 m0, s51, 98304
  s_nop 0
  buffer_load_dwordx4 v4, s[44:47], s48 offen lds
  s_add_u32 s48, s53, 98432
  s_add_u32 m0, s51, 99328
  s_nop 0
  buffer_load_dwordx4 v4, s[44:47], s48 offen lds
  s_add_u32 s48, s53, 98560
  s_add_u32 m0, s51, 100352
  s_nop 0
  buffer_load_dwordx4 v4, s[44:47], s48 offen lds
  s_add_u32 s48, s53, 98688
  s_add_u32 m0, s51, 101376
  s_nop 0
  buffer_load_dwordx4 v4, s[44:47], s48 offen lds
  s_add_u32 s48, s53, 98816
  s_add_u32 m0, s51, 102400
  s_nop 0
  buffer_load_dwordx4 v4, s[44:47], s48 offen lds
  s_add_u32 s48, s53, 98944
  s_add_u32 m0, s51, 103424
  s_nop 0
  buffer_load_dwordx4 v4, s[44:47], s48 offen lds
  s_add_u32 s48, s53, 99072
  s_add_u32 m0, s51, 104448
  s_nop 0
  buffer_load_dwordx4 v4, s[44:47], s48 offen lds
  s_add_u32 s48, s53, 99200
  s_add_u32 m0, s51, 105472
  s_nop 0
  buffer_load_dwordx4 v4, s[44:47], s48 offen lds
L_cp_37:
  s_waitcnt lgkmcnt(0)
  s_mul_i32 s35, s34, 0x9e3779b1
  s_add_u32 s35, s35, 0x7f4a7c15
  s_cmp_ge_u32 s36, 4
  s_cbranch_scc1 L_z_44
L_z_44:
  s_waitcnt vmcnt(0)
  s_barrier
  ds_read_b128 v[188:191], v5 offset:0
  ds_read_b128 v[192:195], v6 offset:0
  ds_read_b128 v[196:199], v5 offset:1024
  ds_read_b128 v[200:203], v6 offset:1024
  ds_read_b128 v[204:207], v5 offset:2048
  ds_read_b128 v[208:211], v6 offset:2048
  ds_read_b128 v[212:215], v5 offset:3072
  ds_read_b128 v[216:219], v6 offset:3072
  ds_read_b128 v[220:223], v5 offset:4096
  ds_read_b128 v[224:227], v6 offset:4096
  ds_read_b128 v[228:231], v5 offset:5120
  ds_read_b128 v[232:235], v6 offset:5120
  ds_read_b128 v[236:239], v5 offset:6144
  ds_read_b128 v[240:243], v6 offset:6144
  ds_read_b128 v[244:247], v5 offset:7168
  ds_read_b128 v[248:251], v6 offset:7168
  s_mov_b32 s56, 0
L_poll_45:
  global_load_dwordx4 v[28:31], v12, s[92:93] offset:-4096 sc1
  global_load_dwordx4 v[32:35], v12, s[94:95] offset:-4096 sc1
  global_load_dwordx4 v[36:39], v12, s[96:97] offset:-4096 sc1
  global_load_dwordx4 v[40:43], v12, s[98:99] offset:-4096 sc1
  s_waitcnt vmcnt(0)
  v_cmp_eq_u32 s[54:55], s35, v31
  v_cmp_eq_u32 vcc, s35, v35
  s_and_b64 s[54:55], s[54:55], vcc
  v_cmp_eq_u32 vcc, s35, v39
  s_and_b64 s[54:55], s[54:55], vcc
  v_cmp_eq_u32 vcc, s35, v43
  s_and_b64 s[54:55], s[54:55], vcc
  s_cmp_eq_u64 s[54:55], -1
  s_cbranch_scc1 L_pdone_46
  s_add_u32 s56, s56, 1
  s_cmp_lt_u32 s56, 200000
  s_sleep 4
  s_cbranch_scc1 L_poll_45
L_pdone_46:
  ds_write_b64 v13, v[28:29] offset:0
  ds_write_b64 v13, v[32:33] offset:4224
  ds_write_b64 v13, v[36:37] offset:8448
  ds_write_b64 v13, v[40:41] offset:12672
L_q_41:
  s_waitcnt lgkmcnt(0)
  s_barrier
  ds_read_b128 v[36:39], v7 offset:0
  ds_read_b128 v[40:43], v7 offset:64
  ds_read_b128 v[44:47], v7 offset:128
  ds_read_b128 v[48:51], v7 offset:192
  s_waitcnt lgkmcnt(3)
  v_mfma_f32_16x16x32_bf16 v[28:31], v[60:63], v[36:39], 0
  v_mfma_f32_16x16x32_bf16 v[32:35], v[188:191], v[36:39], 0
  ds_read_b128 v[52:55], v7 offset:256
  s_waitcnt lgkmcnt(3)
  v_mfma_f32_16x16x32_bf16 v[28:31], v[64:67], v[40:43], v[28:31]
  v_mfma_f32_16x16x32_bf16 v[32:35], v[192:195], v[40:43], v[32:35]
  ds_read_b128 v[36:39], v7 offset:320
  s_waitcnt lgkmcnt(3)
  v_mfma_f32_16x16x32_bf16 v[28:31], v[68:71], v[44:47], v[28:31]
  v_mfma_f32_16x16x32_bf16 v[32:35], v[196:199], v[44:47], v[32:35]
  ds_read_b128 v[40:43], v7 offset:384
  s_waitcnt lgkmcnt(3)
  v_mfma_f32_16x16x32_bf16 v[28:31], v[72:75], v[48:51], v[28:31]
  v_mfma_f32_16x16x32_bf16 v[32:35], v[200:203], v[48:51], v[32:35]
  ds_read_b128 v[44:47], v7 offset:448
  s_waitcnt lgkmcnt(3)
  v_mfma_f32_16x16x32_bf16 v[28:31], v[76:79], v[52:55], v[28:31]
  v_mfma_f32_16x16x32_bf16 v[32:35], v[204:207], v[52:55], v[32:35]
  ds_read_b128 v[48:51], v7 offset:512
  s_waitcnt lgkmcnt(3)
  v_mfma_f32_16x16x32_bf16 v[28:31], v[80:83], v[36:39], v[28:31]
  v_mfma_f32_16x16x32_bf16 v[32:35], v[208:211], v[36:39], v[32:35]
  ds_read_b128 v[52:55], v7 offset:576
  s_waitcnt lgkmcnt(3)
  v_mfma_f32_16x16x32_bf16 v[28:31], v[84:87], v[40:43], v[28:31]
  v_mfma_f32_16x16x32_bf16 v[32:35], v[212:215], v[40:43], v[32:35]
  ds_read_b128 v[36:39], v7 offset:640
  s_waitcnt lgkmcnt(3)
  v_mfma_f32_16x16x32_bf16 v[28:31], v[88:91], v[44:47], v[28:31]
  v_mfma_f32_16x16x32_bf16 v[32:35], v[216:219], v[44:47], v[32:35]
  ds_read_b128 v[40:43], v7 offset:704
  s_waitcnt lgkmcnt(3)
  v_mfma_f32_16x16x32_bf16 v[28:31], v[92:95], v[48:51], v[28:31]
  v_mfma_f32_16x16x32_bf16 v[32:35], v[220:223], v[48:51], v[32:35]
  ds_read_b128 v[44:47], v7 offset:768
  s_waitcnt lgkmcnt(3)
  v_mfma_f32_16x16x32_bf16 v[28:31], v[96:99], v[52:55], v[28:31]
  v_mfma_f32_16x16x32_bf16 v[32:35], v[224:227], v[52:55], v[32:35]
  ds_read_b128 v[48:51], v7 offset:832
  s_waitcnt lgkmcnt(3)
  v_mfma_f32_16x16x32_bf16 v[28:31], v[100:103], v[36:39], v[28:31]
  v_mfma_f32_16x16x32_bf16 v[32:35], v[228:231], v[36:39], v[32:35]
  ds_read_b128 v[52:55], v7 offset:896
  s_waitcnt lgkmcnt(3)
  v_mfma_f32_16x16x32_bf16 v[28:31], v[104:107], v[40:43], v[28:31]
  v_mfma_f32_16x16x32_bf16 v[32:35], v[232:235], v[40:43], v[32:35]
  ds_read_b128 v[36:39], v7 offset:960
  s_waitcnt lgkmcnt(3)
  v_mfma_f32_16x16x32_bf16 v[28:31], v[108:111], v[44:47], v[28:31]
  v_mfma_f32_16x16x32_bf16 v[32:35], v[236:239], v[44:47], v[32:35]
  s_waitcnt lgkmcnt(2)
  v_mfma_f32_16x16x32_bf16 v[28:31], v[112:115], v[48:51], v[28:31]
  v_mfma_f32_16x16x32_bf16 v[32:35], v[240:243], v[48:51], v[32:35]
  s_waitcnt lgkmcnt(1)
  v_mfma_f32_16x16x32_bf16 v[28:31], v[116:119], v[52:55], v[28:31]
  v_mfma_f32_16x16x32_bf16 v[32:35], v[244:247], v[52:55], v[32:35]
  s_waitcnt lgkmcnt(0)
  v_mfma_f32_16x16x32_bf16 v[28:31], v[120:123], v[36:39], v[28:31]
  v_mfma_f32_16x16x32_bf16 v[32:35], v[248:251], v[36:39], v[32:35]
  ds_read_b64_tr_b16 v[188:189], v20 offset:0
  ds_read_b64_tr_b16 v[190:191], v20 offset:16384
  ds_read_b64_tr_b16 v[204:205], v21 offset:0
  ds_read_b64_tr_b16 v[206:207], v21 offset:16384
  ds_read_b64_tr_b16 v[220:221], v22 offset:0
  ds_read_b64_tr_b16 v[222:223], v22 offset:16384
  ds_read_b64_tr_b16 v[236:237], v23 offset:0
  ds_read_b64_tr_b16 v[238:239], v23 offset:16384
  v_max_f32 v16, v28, v29
  v_max3_f32 v17, v30, v31, v32
  v_max3_f32 v16, v16, v33, v34
  v_max3_f32 v16, v16, v35, v17
  v_mov_b32 v17, v16
  ds_read_b64_tr_b16 v[192:193], v20 offset:32768
  ds_read_b64_tr_b16 v[194:195], v20 offset:49152
  v_permlane16_swap_b32 v16, v17
  v_max_f32 v16, v16, v17
  v_mov_b32 v17, v16
  ds_read_b64_tr_b16 v[208:209], v21 offset:32768
  ds_read_b64_tr_b16 v[210:211], v21 offset:49152
  v_permlane32_swap_b32 v16, v17
  v_max_f32 v16, v16, v17
  ds_write_b32 v10, v16
  ds_read_b64_tr_b16 v[224:225], v22 offset:32768
  ds_read_b64_tr_b16 v[226:227], v22 offset:49152
  ds_read_b64_tr_b16 v[240:241], v23 offset:32768
  ds_read_b64_tr_b16 v[242:243], v23 offset:49152
  s_waitcnt lgkmcnt(4)
  s_barrier
  ds_read_b128 v[36:39], v11
  ds_read_b128 v[40:43], v11 offset:16
  ds_read_b64_tr_b16 v[196:197], v24 offset:0
  ds_read_b64_tr_b16 v[198:199], v24 offset:16384
  ds_read_b64_tr_b16 v[212:213], v25 offset:0
  ds_read_b64_tr_b16 v[214:215], v25 offset:16384
  ds_read_b64_tr_b16 v[228:229], v26 offset:0
  ds_read_b64_tr_b16 v[230:231], v26 offset:16384
  ds_read_b64_tr_b16 v[244:245], v27 offset:0
  ds_read_b64_tr_b16 v[246:247], v27 offset:16384
  s_waitcnt lgkmcnt(8)
  v_max3_f32 v16, v36, v37, v38
  v_max3_f32 v17, v39, v40, v41
  v_max3_f32 v19, v16, v42, v43
  v_max_f32 v16, v19, v17
  v_pk_add_f32 v[28:29], v[28:29], v[16:17] op_sel_hi:[1,0] neg_lo:[0,1] neg_hi:[0,1]
  v_pk_add_f32 v[30:31], v[30:31], v[16:17] op_sel_hi:[1,0] neg_lo:[0,1] neg_hi:[0,1]
  v_pk_add_f32 v[32:33], v[32:33], v[16:17] op_sel_hi:[1,0] neg_lo:[0,1] neg_hi:[0,1]
  v_pk_add_f32 v[34:35], v[34:35], v[16:17] op_sel_hi:[1,0] neg_lo:[0,1] neg_hi:[0,1]
  v_exp_f32 v28, v28
  v_exp_f32 v29, v29
  v_exp_f32 v30, v30
  v_exp_f32 v31, v31
  v_exp_f32 v32, v32
  v_cvt_pk_bf16_f32 v36, v28, v29
  v_exp_f32 v33, v33
  v_cvt_pk_bf16_f32 v37, v30, v31
  v_exp_f32 v34, v34
  ds_write_b64 v9, v[36:37]
  v_exp_f32 v35, v35
  v_cvt_pk_bf16_f32 v38, v32, v33
  v_pk_add_f32 v[28:29], v[28:29], v[30:31]
  v_cvt_pk_bf16_f32 v39, v34, v35
  v_pk_add_f32 v[32:33], v[32:33], v[34:35]
  ds_write_b64 v9, v[38:39] offset:256
  v_pk_add_f32 v[28:29], v[28:29], v[32:33]
  v_add_f32 v18, v28, v29
  v_mov_b32 v17, v18
  ds_read_b64_tr_b16 v[200:201], v24 offset:32768
  ds_read_b64_tr_b16 v[202:203], v24 offset:49152
  v_permlane16_swap_b32 v18, v17
  v_add_f32 v18, v18, v17
  v_mov_b32 v17, v18
  ds_read_b64_tr_b16 v[216:217], v25 offset:32768
  ds_read_b64_tr_b16 v[218:219], v25 offset:49152
  v_permlane32_swap_b32 v18, v17
  v_add_f32 v18, v18, v17
  ds_write_b32 v10, v18 offset:512
  ds_read_b64_tr_b16 v[232:233], v26 offset:32768
  ds_read_b64_tr_b16 v[234:235], v26 offset:49152
  ds_read_b64_tr_b16 v[248:249], v27 offset:32768
  ds_read_b64_tr_b16 v[250:251], v27 offset:49152
  s_waitcnt lgkmcnt(4)
  s_barrier
  ds_read_b128 v[60:63], v8 offset:0
  ds_read_b128 v[64:67], v8 offset:64
  ds_read_b128 v[68:71], v8 offset:128
  ds_read_b128 v[72:75], v8 offset:192
  s_waitcnt lgkmcnt(3)
  v_mfma_f32_16x16x32_bf16 v[36:39], v[124:127], v[60:63], 0
  v_mfma_f32_16x16x32_bf16 v[40:43], v[140:143], v[60:63], 0
  v_mfma_f32_16x16x32_bf16 v[44:47], v[156:159], v[60:63], 0
  v_mfma_f32_16x16x32_bf16 v[48:51], v[172:175], v[60:63], 0
  ds_read_b128 v[60:63], v8 offset:256
  s_waitcnt lgkmcnt(3)
  v_mfma_f32_16x16x32_bf16 v[36:39], v[128:131], v[64:67], v[36:39]
  v_mfma_f32_16x16x32_bf16 v[40:43], v[144:147], v[64:67], v[40:43]
  v_mfma_f32_16x16x32_bf16 v[44:47], v[160:163], v[64:67], v[44:47]
  v_mfma_f32_16x16x32_bf16 v[48:51], v[176:179], v[64:67], v[48:51]
  ds_read_b128 v[64:67], v8 offset:320
  v_mul_u32_u24 v88, 192, v2
  v_lshl_add_u32 v88, v3, 4, v88
  s_mul_i32 s49, s36, 3072
  v_add_u32 v88, s49, v88
  v_lshl_add_u32 v89, v1, 4, s49
  s_mul_i32 s48, s41, 24576
  s_add_u32 s48, s48, 790528
  v_add_u32 v92, s48, v89
  v_mov_b32 v79, s35
  v_mov_b32 v83, s35
  v_mov_b32 v87, s35
  s_waitcnt lgkmcnt(3)
  v_mfma_f32_16x16x32_bf16 v[36:39], v[132:135], v[68:71], v[36:39]
  v_mfma_f32_16x16x32_bf16 v[40:43], v[148:151], v[68:71], v[40:43]
  v_mfma_f32_16x16x32_bf16 v[44:47], v[164:167], v[68:71], v[44:47]
  v_mfma_f32_16x16x32_bf16 v[48:51], v[180:183], v[68:71], v[48:51]
  ds_read_b128 v[68:71], v8 offset:384
  s_waitcnt lgkmcnt(3)
  v_mfma_f32_16x16x32_bf16 v[36:39], v[136:139], v[72:75], v[36:39]
  v_mfma_f32_16x16x32_bf16 v[40:43], v[152:155], v[72:75], v[40:43]
  v_mfma_f32_16x16x32_bf16 v[44:47], v[168:171], v[72:75], v[44:47]
  v_mfma_f32_16x16x32_bf16 v[48:51], v[184:187], v[72:75], v[48:51]
  ds_read_b128 v[72:75], v8 offset:448
  s_waitcnt lgkmcnt(3)
  v_mfma_f32_16x16x32_bf16 v[36:39], v[188:191], v[60:63], v[36:39]
  v_mfma_f32_16x16x32_bf16 v[40:43], v[204:207], v[60:63], v[40:43]
  v_mfma_f32_16x16x32_bf16 v[44:47], v[220:223], v[60:63], v[44:47]
  v_mfma_f32_16x16x32_bf16 v[48:51], v[236:239], v[60:63], v[48:51]
  ds_read_b128 v[28:31], v11 offset:512
  ds_read_b128 v[32:35], v11 offset:528
  s_waitcnt lgkmcnt(2)
  v_mfma_f32_16x16x32_bf16 v[36:39], v[192:195], v[64:67], v[36:39]
  v_mfma_f32_16x16x32_bf16 v[40:43], v[208:211], v[64:67], v[40:43]
  v_mfma_f32_16x16x32_bf16 v[44:47], v[224:227], v[64:67], v[44:47]
  v_mfma_f32_16x16x32_bf16 v[48:51], v[240:243], v[64:67], v[48:51]
  s_waitcnt lgkmcnt(1)
  v_mfma_f32_16x16x32_bf16 v[36:39], v[196:199], v[68:71], v[36:39]
  v_mfma_f32_16x16x32_bf16 v[40:43], v[212:215], v[68:71], v[40:43]
  v_mfma_f32_16x16x32_bf16 v[44:47], v[228:231], v[68:71], v[44:47]
  v_mfma_f32_16x16x32_bf16 v[48:51], v[244:247], v[68:71], v[48:51]
  s_waitcnt lgkmcnt(0)
  v_add_f32 v28, v28, v29
  v_add_f32 v30, v30, v31
  v_add_f32 v32, v32, v33
  v_add_f32 v34, v34, v35
  v_add_f32 v28, v28, v30
  v_add_f32 v32, v32, v34
  v_add_f32 v18, v28, v32
  v_cndmask_b32 v86, v16, v18, s[62:63]
  s_waitcnt lgkmcnt(0)
  v_mfma_f32_16x16x32_bf16 v[36:39], v[200:203], v[72:75], v[36:39]
  v_mfma_f32_16x16x32_bf16 v[40:43], v[216:219], v[72:75], v[40:43]
  v_mfma_f32_16x16x32_bf16 v[44:47], v[232:235], v[72:75], v[44:47]
  v_mfma_f32_16x16x32_bf16 v[48:51], v[248:251], v[72:75], v[48:51]
  s_nop 4
  v_cvt_pk_bf16_f32 v76, v36, v37
  v_cvt_pk_bf16_f32 v77, v38, v39
  s_nop 0
  v_cvt_pk_bf16_f32 v78, v48, v49
  ds_write_b128 v88, v[76:79]
  v_cvt_pk_bf16_f32 v80, v40, v41
  v_cvt_pk_bf16_f32 v81, v42, v43
  v_cvt_pk_bf16_f32 v82, v50, v51
  ds_write_b128 v88, v[80:83] offset:64
  v_cvt_pk_bf16_f32 v84, v44, v45
  v_cvt_pk_bf16_f32 v85, v46, v47
  ds_write_b128 v88, v[84:87] offset:128
  s_waitcnt lgkmcnt(0)
  ds_read_b128 v[96:99], v89 offset:0
  ds_read_b128 v[100:103], v89 offset:1024
  ds_read_b128 v[104:107], v89 offset:2048
  s_waitcnt lgkmcnt(2)
  global_store_dwordx4 v92, v[96:99], s[32:33] offset:0 sc1
  s_waitcnt lgkmcnt(1)
  global_store_dwordx4 v92, v[100:103], s[32:33] offset:1024 sc1
  s_waitcnt lgkmcnt(0)
  global_store_dwordx4 v92, v[104:107], s[32:33] offset:2048 sc1
  s_and_b32 s42, s43, 15
  s_cmp_ge_u32 s42, 9
  s_cbranch_scc1 L_fin_47
  s_lshr_b32 s48, s43, 4
  s_mul_i32 s48, s48, 9
  s_add_u32 s48, s48, s42
  s_lshl_b32 s49, s48, 7
  s_add_u32 s49, s49, 3936256
  v_lshrrev_b32 v24, 3, v0
  v_mul_u32_u24 v24, 9216, v24
  v_and_b32 v25, 7, v0
  v_lshl_add_u32 v24, v25, 4, v24
  v_add_u32 v24, s49, v24
  v_add_u32 v26, 589824, v24
  s_lshr_b32 s84, s48, 1
  s_cmp_ge_u32 s84, 18
  s_cselect_b32 s49, 18, 0
  s_cselect_b32 s50, 1, 0
  s_sub_u32 s85, s84, s49
  v_mov_b32 v84, 0
  s_cmp_lt_u32 s85, 12
  s_cbranch_scc1 L_b5_48
  s_and_b32 s49, s48, 1
  s_lshl_b32 s49, s49, 1
  s_lshr_b32 s51, s36, 2
  s_add_u32 s49, s49, s51
  s_lshl_b32 s49, s49, 1
  s_add_u32 s49, s49, s50
  s_lshl_b32 s49, s49, 4
  s_and_b32 s51, s36, 3
  s_lshl_b32 s51, s51, 2
  s_add_u32 s49, s49, s51
  s_mul_i32 s49, s49, 1536
  s_lshr_b32 s50, s85, 1
  s_sub_u32 s50, s50, 6
  s_lshl_b32 s50, s50, 9
  s_add_u32 s49, s49, s50
  s_and_b32 s50, s85, 1
  s_lshl_b32 s50, s50, 8
  s_add_u32 s49, s49, s50
  s_add_u32 s49, s49, 5115904
  v_mul_u32_u24 v28, 1536, v3
  v_lshl_add_u32 v28, v2, 4, v28
  v_add_u32 v28, s49, v28
  s_mov_b32 s56, 0
L_poll_49:
  global_load_dwordx4 v[84:87], v28, s[32:33] sc1
  s_waitcnt vmcnt(0)
  v_cmp_eq_u32 s[54:55], s35, v87
  s_cmp_eq_u64 s[54:55], -1
  s_cbranch_scc1 L_pdone_50
  s_add_u32 s56, s56, 1
  s_cmp_lt_u32 s56, 200000
  s_sleep 1
  s_cbranch_scc1 L_poll_49
L_pdone_50:
  v_mov_b32 v85, v84
  s_nop 1
  v_permlane16_swap_b32 v84, v85
  v_add_f32 v84, v84, v85
  v_mov_b32 v85, v84
  s_nop 1
  v_permlane32_swap_b32 v84, v85
  v_add_f32 v84, v84, v85
  s_lshr_b32 s51, s36, 2
  v_lshrrev_b32 v29, 4, v1
  v_cmp_eq_u32 vcc, s51, v29
  s_nop 1
  v_cndmask_b32 v84, 0, v84, vcc
L_b5_48:
  v_and_b32 v29, 31, v1
  v_lshlrev_b32 v29, 2, v29
  s_lshl_b32 s49, s36, 7
  s_add_u32 s49, s49, 33792
  v_add_u32 v29, s49, v29
  s_mov_b32 exec_hi, 0
  ds_write_b32 v29, v84
  s_mov_b64 exec, -1
  s_waitcnt lgkmcnt(0)
  s_barrier
  v_lshlrev_b32 v31, 2, v1
  v_add_u32 v31, 32768, v31
  ds_read_b32 v72, v31 offset:1024
  ds_read_b32 v73, v31 offset:1152
  ds_read_b32 v74, v31 offset:1280
  ds_read_b32 v75, v31 offset:1408
  ds_read_b32 v76, v31 offset:1536
  ds_read_b32 v77, v31 offset:1664
  ds_read_b32 v78, v31 offset:1792
  ds_read_b32 v79, v31 offset:1920
  v_and_b32 v30, 7, v1
  v_lshlrev_b32 v30, 4, v30
  s_lshl_b32 s49, s36, 7
  s_add_u32 s49, s49, 32768
  v_add_u32 v30, s49, v30
  s_and_b32 s49, s48, 1
  s_mul_i32 s49, s49, 2304
  s_lshl_b32 s50, s84, 5
  s_add_u32 s49, s49, s50
  v_lshrrev_b32 v32, 4, v1
  v_mul_u32_u24 v32, 1152, v32
  v_lshl_add_u32 v32, v2, 1, v32
  v_add_u32 v32, s49, v32
  s_mov_b32 s50, 0xffffff00
  s_mov_b32 s51, 0x00040c0c
  s_mov_b32 s52, 0x0706000c
  s_waitcnt lgkmcnt(0)
  v_add_f32 v72, v72, v73
  v_add_f32 v74, v74, v75
  v_add_f32 v76, v76, v77
  v_add_f32 v78, v78, v79
  v_add_f32 v72, v72, v74
  v_add_f32 v76, v76, v78
  v_add_f32 v33, v72, v76
  s_mov_b32 s56, 0
L_poll_51:
  global_load_dwordx4 v[64:67], v24, s[32:33] sc1
  global_load_dwordx4 v[68:71], v26, s[32:33] sc1
  s_waitcnt vmcnt(0)
  v_cmp_eq_u32 s[54:55], s35, v67
  v_cmp_eq_u32 vcc, s35, v71
  s_and_b64 s[54:55], s[54:55], vcc
  s_cmp_eq_u64 s[54:55], -1
  s_cbranch_scc1 L_pdone_52
  s_add_u32 s56, s56, 1
  s_cmp_lt_u32 s56, 200000
  s_sleep 1
  s_cbranch_scc1 L_poll_51
L_pdone_52:
  v_perm_b32 v75, v65, v64, s51
  v_and_b32 v72, s50, v64
  v_and_b32 v73, s50, v65
  v_perm_b32 v75, v75, v66, s52
  v_and_b32 v74, s50, v66
  v_perm_b32 v79, v69, v68, s51
  v_and_b32 v76, s50, v68
  v_and_b32 v77, s50, v69
  v_perm_b32 v79, v79, v70, s52
  v_and_b32 v78, s50, v70
  v_add_f32 v72, v72, v76
  v_add_f32 v73, v73, v77
  v_add_f32 v74, v74, v78
  v_add_f32 v75, v75, v79
  v_add_f32_dpp v72, v72, v72 row_ror:8 row_mask:0xf bank_mask:0xf
  v_add_f32_dpp v73, v73, v73 row_ror:8 row_mask:0xf bank_mask:0xf
  v_add_f32_dpp v74, v74, v74 row_ror:8 row_mask:0xf bank_mask:0xf
  v_add_f32_dpp v75, v75, v75 row_ror:8 row_mask:0xf bank_mask:0xf
  v_mov_b32 v76, v72
  v_mov_b32 v77, v73
  v_mov_b32 v78, v74
  v_mov_b32 v79, v75
  v_permlane16_swap_b32 v72, v76
  v_permlane16_swap_b32 v73, v77
  v_permlane16_swap_b32 v74, v78
  v_permlane16_swap_b32 v75, v79
  v_add_f32 v72, v72, v76
  v_add_f32 v73, v73, v77
  v_add_f32 v74, v74, v78
  v_add_f32 v75, v75, v79
  v_mov_b32 v76, v72
  v_mov_b32 v77, v73
  v_mov_b32 v78, v74
  v_mov_b32 v79, v75
  v_permlane32_swap_b32 v72, v76
  v_permlane32_swap_b32 v73, v77
  v_permlane32_swap_b32 v74, v78
  v_permlane32_swap_b32 v75, v79
  v_add_f32 v72, v72, v76
  v_add_f32 v73, v73, v77
  v_add_f32 v74, v74, v78
  v_add_f32 v75, v75, v79
  s_mov_b64 exec, 0xff
  ds_write_b128 v30, v[72:75]
  s_mov_b64 exec, -1
  s_waitcnt lgkmcnt(0)
  s_barrier
  s_cmp_lg_u32 s36, 0
  s_cbranch_scc1 L_fw_53
  ds_read_b32 v72, v31 offset:0
  ds_read_b32 v73, v31 offset:128
  ds_read_b32 v74, v31 offset:256
  ds_read_b32 v75, v31 offset:384
  ds_read_b32 v76, v31 offset:512
  ds_read_b32 v77, v31 offset:640
  ds_read_b32 v78, v31 offset:768
  ds_read_b32 v79, v31 offset:896
  s_waitcnt lgkmcnt(4)
  v_add_f32 v72, v72, v73
  v_add_f32 v74, v74, v75
  v_add_f32 v72, v72, v33
  s_waitcnt lgkmcnt(0)
  v_add_f32 v76, v76, v77
  v_add_f32 v78, v78, v79
  v_add_f32 v72, v72, v74
  v_add_f32 v76, v76, v78
  v_add_f32 v72, v72, v76
  v_cvt_pk_bf16_f32 v72, v72, v72
  s_mov_b32 exec_hi, 0
  global_store_short v32, v72, s[28:29]
  s_mov_b64 exec, -1
  s_cmp_lg_u32 s48, 0
  s_cbranch_scc1 L_fw_53
  s_add_u32 s49, s34, 1
  v_mov_b32 v34, s49
  v_mov_b32 v35, 0
  s_mov_b64 exec, 1
  global_store_dword v35, v34, s[32:33] sc1
  s_mov_b64 exec, -1
L_fw_53:
L_fin_47:
  s_endpgm
L_end:
  s_endpgm
L_text_end:
.section .rodata,"a"
.p2align 6
.amdhsa_kernel gated_mix__compressed_kv_cla__mixer_token_mlp__decode_kernel
  .amdhsa_next_free_vgpr 256
  .amdhsa_next_free_sgpr 102
  .amdhsa_accum_offset 256
  .amdhsa_group_segment_fixed_size 0
  .amdhsa_kernarg_size 120
  .amdhsa_user_sgpr_count 2
  .amdhsa_user_sgpr_kernarg_segment_ptr 1
  .amdhsa_system_sgpr_workgroup_id_x 1
.end_amdhsa_kernel
```
